```python
import torch

def _softmax(x, axis=-1):
    return torch.softmax(x, dim=axis)

def _gelu(x):
    return torch.nn.functional.gelu(x, approximate='tanh')

def _silu(x):
    return torch.nn.functional.silu(x)

def _sigmoid(x):
    return torch.sigmoid(x)

def _layernorm(x, axis=-1, eps=1e-05):
    m = x.mean(dim=axis, keepdim=True)
    v = x.var(dim=axis, keepdim=True, unbiased=False)
    return (x - m) / torch.sqrt(v + eps)

def _scatter_add(tgt, idx, src, axis=0):
    return tgt.clone().index_add_(axis, idx, src)

def _segment_sum(src, seg, n):
    out = torch.zeros((n,) + src.shape[1:], dtype=src.dtype)
    return out.index_add_(0, seg, src)

def _pad(x, pw):
    flat = tuple((v for pair in reversed(pw) for v in pair))
    return torch.nn.functional.pad(x, flat)
kernel_name = 'adaLN_cond__ssm_conv_s4__dense_activation_silu__prompt'

def setup_inputs():

    _w = lambda a: (lambda t: t.to(torch.bfloat16) if t.is_floating_point() else t)(torch.as_tensor(a))

    def _A_setup():
        B, L, D, N = (1, 2048, 512, 128)
        A_re = -(lambda _x: torch.exp(torch.as_tensor(_x)))((lambda *s: torch.randn(*s, dtype=torch.bfloat16) * 3.2)(D, N))
        A_im = torch.pi * (lambda *s: torch.randn(*s, dtype=torch.bfloat16) * 0.05)(D, N)
        B_re = (lambda *s: torch.randn(*s, dtype=torch.bfloat16) * 0.1)(D, N)
        B_im = (lambda *s: torch.randn(*s, dtype=torch.bfloat16) * 0.1)(D, N)
        C_re = (lambda *s: torch.randn(*s, dtype=torch.bfloat16) * 0.1)(D, N)
        C_im = (lambda *s: torch.randn(*s, dtype=torch.bfloat16) * 0.1)(D, N)
        log_dt = (lambda *s: torch.randn(*s, dtype=torch.bfloat16) * 0.05)(D) * 0.5 - 4.0
        Dskip = (lambda *s: torch.randn(*s, dtype=torch.bfloat16) * 0.05)(D)
        return {'u': _w((lambda *s: torch.randn(*s, dtype=torch.bfloat16) * 0.05)(B, L, D)), 'A_re': _w(A_re), 'A_im': _w(A_im), 'B_re': _w(B_re), 'B_im': _w(B_im), 'C_re': _w(C_re), 'C_im': _w(C_im), 'log_dt': _w(log_dt), 'Dskip': _w(Dskip)}
    _A_in = _A_setup()

    def _B_setup():
        B, S, D, F = (1, 2048, 512, 1792)
        return {'x': _w((lambda *s: torch.randn(*s, dtype=torch.bfloat16) * 0.05)(B, S, D)), 'w1': _w((lambda *s: torch.randn(*s, dtype=torch.bfloat16) * 3.2)(D, F) * D ** (-0.5)), 'w2': _w((lambda *s: torch.randn(*s, dtype=torch.bfloat16) * 0.4)(F, D) * F ** (-0.5))}
    _B_in = _B_setup()
    return {'A_u': _A_in['u'], 'A_A_re': _A_in['A_re'], 'A_A_im': _A_in['A_im'], 'A_B_re': _A_in['B_re'], 'A_B_im': _A_in['B_im'], 'A_C_re': _A_in['C_re'], 'A_C_im': _A_in['C_im'], 'A_log_dt': _A_in['log_dt'], 'A_Dskip': _A_in['Dskip'], 'B_x': _B_in['x'], 'B_w1': _B_in['w1'], 'B_w2': _B_in['w2'], 'c': _w((lambda *s: torch.randn(*s, dtype=torch.bfloat16) * 0.2)(1, 512) * 8.0), 'w_mod': _w((lambda *s: torch.randn(*s, dtype=torch.bfloat16) * 0.2)(512, 6 * 512) * 512 ** (-0.5) * 8.0)}

def reference(A_u, A_A_re, A_A_im, A_B_re, A_B_im, A_C_re, A_C_im, A_log_dt, A_Dskip, B_x, B_w1, B_w2, c, w_mod):

    def _A_ref(u, A_re, A_im, B_re, B_im, C_re, C_im, log_dt, Dskip):
        Bsz, L, D = u.shape
        dt = torch.exp(log_dt)[:, None]
        A = A_re + 1j * A_im
        Bc = B_re + 1j * B_im
        Cc = C_re + 1j * C_im
        logdA = dt * A
        dB = dt * Bc
        l = (lambda x, dt: x.to(dt))(torch.arange(L), A_re.dtype)
        P = torch.exp(logdA[:, :, None] * l[None, None, :])
        K = torch.einsum('dn,dnl,dn->dl', Cc, P, dB).real
        L2 = 2 * L
        Kp = _pad(K, ((0, 0), (0, L)))
        up = (lambda x, *d: x.permute(*d))(u, 0, 2, 1)
        up = _pad(up, ((0, 0), (0, 0), (0, L)))
        Kf = (lambda x, axes=(-2, -1): torch.fft.rfft2(x.float(), dim=axes))(Kp[:, None, :], axes=(-2, -1))
        Uf = (lambda x, axes=(-2, -1): torch.fft.rfft2(x.float(), dim=axes))(up[:, :, None, :], axes=(-2, -1))
        Yf = Uf * Kf[None, :, :, :]
        y = (lambda x, s, axes=(-2, -1): torch.fft.irfft2(x, s=s, dim=axes).to(torch.bfloat16))(Yf, (1, L2), axes=(-2, -1))[:, :, 0, :L]
        y = (lambda x, *d: x.permute(*d))(y, 0, 2, 1) + u * Dskip[None, None, :]
        return y

    def _B_ref(x, w1, w2):
        h = torch.einsum('bsd,df->bsf', x, w1)
        h = _silu(h)
        out = torch.einsum('bsf,fd->bsd', h, w2)
        return out
    x = A_u
    mod = (_silu(c) @ w_mod).reshape(c.shape[0], 6, 1, -1)
    sa, ca, ga, sb, cb, gb = (mod[:, 0].clone(), mod[:, 1].clone(), mod[:, 2].clone(), mod[:, 3].clone(), mod[:, 4].clone(), mod[:, 5].clone())
    h = _layernorm(x, axis=-1) * (1 + ca) + sa
    x = x + ga * _A_ref(h, A_A_re, A_A_im, A_B_re, A_B_im, A_C_re, A_C_im, A_log_dt, A_Dskip)
    h = _layernorm(x, axis=-1) * (1 + cb) + sb
    x = x + gb * _B_ref(h, B_w1, B_w2)
    return x
```

```asm
; @launch grid=(256,1,1) block=(256,1,1) lds=132352
.amdgcn_target "amdgcn-amd-amdhsa--gfx950"
.text
.globl adaLN_cond__ssm_conv_s4__dense_activation_silu__prompt_kernel
.type adaLN_cond__ssm_conv_s4__dense_activation_silu__prompt_kernel,@function
.p2align 8
adaLN_cond__ssm_conv_s4__dense_activation_silu__prompt_kernel:
    s_cmp_ge_u32 s2, 256
    s_cbranch_scc1 k_end
    s_cmp_ge_u32 s2, 64
    s_cbranch_scc1 k_nopf
    s_getpc_b64 s[40:41]
k_pc:
    s_and_b32 s42, s2, 8
    s_lshl_b32 s42, s42, 12
    v_lshl_add_u32 v1, v0, 7, s42
    v_cmp_gt_u32 vcc, code_end-k_pc, v1
    s_nop 1
    s_and_saveexec_b64 s[42:43], vcc
    s_cbranch_execz k_pf1
    global_load_dword v127, v1, s[40:41]
k_pf1:
    s_mov_b64 exec, s[42:43]
k_nopf:
    s_load_dwordx16 s[64:79], s[0:1], 0
    s_load_dwordx16 s[80:95], s[0:1], 64
    s_load_dwordx2 s[4:5], s[0:1], 128
    v_lshrrev_b32 v12, 6, v0
    s_nop 0
    v_readfirstlane_b32 s9, v12
    s_lshr_b32 s3, s2, 3
    s_lshl_b32 s3, s3, 4
    s_and_b32 s20, s2, 7
    s_add_u32 s3, s3, s20
    v_lshrrev_b32 v11, 7, v0
    v_lshl_add_u32 v3, v11, 3, s3
    v_and_b32 v1, 127, v0
    v_lshl_add_u32 v1, v3, 7, v1
    v_lshlrev_b32 v1, 1, v1
    v_lshlrev_b32 v3, 1, v3
    v_and_b32 v2, 63, v0
    v_mov_b32 v4, 0
    v_mov_b32 v5, 0
    v_mov_b32 v6, 0
    v_mov_b32 v7, 0
    v_mov_b32 v8, 0
    v_mov_b32 v9, 0
    v_mov_b32 v10, 0
    v_mov_b32 v20, 0
    v_mov_b32 v21, 0
    v_mov_b32 v22, 0
    v_mov_b32 v23, 0
    s_sub_u32 s23, s2, 208
    s_lshl_b32 s21, s23, 12
    s_add_u32 s21, s21, 0x80000
    v_lshl_add_u32 v18, v2, 4, s21
    s_sub_u32 s40, s9, 1
    s_mov_b32 s13, 0
    v_mov_b32 v31, 0
    v_mov_b32 v32, 1
    v_mov_b32 v131, 0
    v_mov_b32 v132, 0
    v_mov_b32 v133, 0
    v_mov_b32 v134, 0
    v_mov_b32 v200, 0
    v_mov_b32 v202, 0
    v_mov_b32 v203, 0
    v_mov_b32 v35, 97216
    ds_write_b32 v35, v31
    s_nop 0
    s_cmp_eq_u32 s9, 3
    s_cbranch_scc1 p1_w_2
    s_cmp_lg_u32 s9, 0
    s_cbranch_scc1 p1_m_1
    s_lshl_b32 s31, s2, 13
    v_lshl_add_u32 v131, v2, 4, s31
    v_add_u32 v132, 4096, v131
    s_mov_b32 s36, 0x05040100
    s_mov_b32 s37, 0x07060302
    v_and_b32 v135, 7, v2
    v_mul_u32_u24 v135, 1040, v135
    v_bfe_u32 v200, v2, 3, 1
    v_lshl_add_u32 v135, v200, 9, v135
    v_bfe_u32 v200, v2, 4, 2
    v_lshl_add_u32 v135, v200, 4, v135
    v_add_u32 v135, 84224, v135
    v_mov_b32 v204, 0x3f803f80
    v_mov_b32 v205, 0x3f803f80
    v_mov_b32 v206, 0x3f803f80
    v_mov_b32 v207, 0x3f803f80
    v_and_b32 v201, 15, v2
    v_lshrrev_b32 v202, 2, v201
    v_lshl_add_u32 v202, v202, 4, v201
    v_lshlrev_b32 v202, 2, v202
    v_and_b32 v203, 3, v2
    s_lshl_b32 s31, s2, 6
    s_add_u32 s31, s31, 0x8000
    v_lshl_add_u32 v133, v2, 2, s31
    s_nop 1
    s_branch p1_a
p1_m_1:
    s_min_u32 s42, s2, 191
    s_lshr_b32 s38, s42, 2
    s_lshl_b32 s38, s38, 1
    s_add_u32 s38, s38, s40
    s_and_b32 s39, s42, 3
    s_lshl_b32 s31, s39, 8
    v_lshl_add_u32 v132, v2, 2, s31
    v_lshrrev_b32 v129, 2, v2
    v_mul_u32_u24 v133, 6144, v129
    v_and_b32 v130, 3, v2
    v_lshl_add_u32 v133, v130, 4, v133
    s_mul_i32 s31, s39, 786432
    s_lshl_b32 s41, s38, 6
    s_add_u32 s31, s31, s41
    v_add_u32 v133, s31, v133
    s_mul_i32 s41, s40, 8448
    s_add_u32 s41, s41, 97280
    v_lshl_add_u32 v135, v2, 2, s41
    v_lshrrev_b32 v134, 4, v2
    v_lshl_add_u32 v201, v134, 4, s41
    v_and_b32 v129, 3, v129
    v_lshl_add_u32 v134, v134, 3, v129
    v_lshl_add_u32 v134, v134, 6, s41
    v_lshl_add_u32 v134, v130, 3, v134
    s_lshl_b32 s31, s38, 7
    s_mul_i32 s39, s39, 12288
    s_add_u32 s31, s31, s39
    s_add_u32 s31, s31, 0x30000
    v_lshl_add_u32 v200, v2, 2, s31
    s_cmp_lt_u32 s2, 192
    s_cselect_b32 s31, -1, 0
    v_and_b32 v133, s31, v133
    s_nop 1
    s_branch p1_a
p1_w_2:
    s_lshr_b32 s38, s2, 2
    s_and_b32 s39, s2, 3
    s_lshl_b32 s38, s38, 15
    v_lshrrev_b32 v129, 4, v2
    v_and_b32 v130, 15, v2
    s_lshl_b32 s31, s39, 8
    s_add_u32 s31, s31, s38
    v_lshl_add_u32 v131, v129, 13, s31
    v_lshl_add_u32 v131, v130, 4, v131
    v_add_u32 v132, 4096, v131
    s_lshl_b32 s31, s39, 10
    s_add_u32 s31, s31, s38
    s_add_u32 s31, s31, 0x100000
    v_lshl_add_u32 v133, v130, 6, s31
    v_lshl_add_u32 v133, v129, 4, v133
    s_mov_b32 s36, 0x05040100
    s_mov_b32 s37, 0x07060302
p1_a:
    s_cmp_eq_u32 s9, 1
    s_cselect_b32 s22, s23, 255
    s_sub_u32 s23, s22, 25
    s_waitcnt lgkmcnt(0)
    s_barrier
    s_cmp_ge_u32 s22, 33
    s_cbranch_scc1 p1_nz
    global_store_dwordx4 v18, v[20:23], s[4:5] offset:0 sc1
    global_store_dwordx4 v18, v[20:23], s[4:5] offset:1024 sc1
    global_store_dwordx4 v18, v[20:23], s[4:5] offset:2048 sc1
    global_store_dwordx4 v18, v[20:23], s[4:5] offset:3072 sc1
p1_nz:
    global_load_short_d16_hi v4, v1, s[66:67] nt
    global_load_short_d16_hi v5, v1, s[68:69] nt
    global_load_short_d16_hi v10, v3, s[78:79]
    global_load_short_d16_hi v6, v1, s[70:71] nt
    global_load_short_d16_hi v7, v1, s[72:73] nt
    global_load_short_d16_hi v8, v1, s[74:75] nt
    global_load_short_d16_hi v9, v1, s[76:77] nt
    s_cmp_eq_u32 s9, 3
    s_cbranch_scc1 p1_w_4
    s_cmp_lg_u32 s9, 0
    s_cbranch_scc1 p1_m_3
    s_mov_b32 m0, 84224
    s_nop 0
    global_load_lds_dwordx4 v131, s[64:65] offset:0
    s_mov_b32 m0, 84240
    s_nop 0
    global_load_lds_dwordx4 v131, s[64:65] offset:1024
    s_mov_b32 m0, 84256
    s_nop 0
    global_load_lds_dwordx4 v131, s[64:65] offset:2048
    s_mov_b32 m0, 84272
    s_nop 0
    global_load_lds_dwordx4 v131, s[64:65] offset:3072
    s_mov_b32 m0, 88384
    s_nop 0
    global_load_lds_dwordx4 v132, s[64:65] offset:0
    s_mov_b32 m0, 88400
    s_nop 0
    global_load_lds_dwordx4 v132, s[64:65] offset:1024
    s_mov_b32 m0, 88416
    s_nop 0
    global_load_lds_dwordx4 v132, s[64:65] offset:2048
    s_mov_b32 m0, 88432
    s_nop 0
    global_load_lds_dwordx4 v132, s[64:65] offset:3072
    s_branch p1_l
p1_m_3:
    global_load_dword v136, v132, s[88:89]
    s_add_u32 m0, s41, 0
    s_nop 0
    global_load_lds_dwordx4 v133, s[90:91]
    v_add_u32 v133, 98304, v133
    s_add_u32 m0, s41, 1024
    s_nop 0
    global_load_lds_dwordx4 v133, s[90:91]
    v_add_u32 v133, 98304, v133
    s_add_u32 m0, s41, 2048
    s_nop 0
    global_load_lds_dwordx4 v133, s[90:91]
    v_add_u32 v133, 98304, v133
    s_add_u32 m0, s41, 3072
    s_nop 0
    global_load_lds_dwordx4 v133, s[90:91]
    v_add_u32 v133, 98304, v133
    s_add_u32 m0, s41, 4096
    s_nop 0
    global_load_lds_dwordx4 v133, s[90:91]
    v_add_u32 v133, 98304, v133
    s_add_u32 m0, s41, 5120
    s_nop 0
    global_load_lds_dwordx4 v133, s[90:91]
    v_add_u32 v133, 98304, v133
    s_add_u32 m0, s41, 6144
    s_nop 0
    global_load_lds_dwordx4 v133, s[90:91]
    v_add_u32 v133, 98304, v133
    s_add_u32 m0, s41, 7168
    s_nop 0
    global_load_lds_dwordx4 v133, s[90:91]
    s_branch p1_l
p1_w_4:
    global_load_dwordx4 v[136:139], v131, s[64:65] offset:0
    global_load_dwordx4 v[140:143], v131, s[64:65] offset:1024
    global_load_dwordx4 v[144:147], v131, s[64:65] offset:2048
    global_load_dwordx4 v[148:151], v131, s[64:65] offset:3072
    global_load_dwordx4 v[152:155], v132, s[64:65] offset:0
    global_load_dwordx4 v[156:159], v132, s[64:65] offset:1024
    global_load_dwordx4 v[160:163], v132, s[64:65] offset:2048
    global_load_dwordx4 v[164:167], v132, s[64:65] offset:3072
p1_l:
    s_cmp_ge_u32 s23, 8
    s_cbranch_scc1 p1_nz2
    s_waitcnt vmcnt(16)
    s_mov_b64 exec, 1
    global_atomic_add v31, v32, s[94:95] sc1
    s_mov_b64 exec, -1
p1_nz2:
    s_mul_i32 s25, s9, 15520
    v_and_b32 v15, 15, v0
    v_bfe_u32 v16, v0, 4, 2
    s_mov_b32 m0, s25
    v_mul_u32_u24 v17, 272, v15
    v_add_u32 v17, s25, v17
    v_lshl_add_u32 v17, v16, 4, v17
    v_mul_u32_u24 v19, 3088, v12
    v_add_u32 v19, 71808, v19
    v_mov_b32 v99, 0x3f80
    ds_write_addtid_b32 v99
    v_lshrrev_b32 v24, 1, v16
    v_lshlrev_b32 v24, 7, v24
    v_and_b32 v25, 1, v16
    v_lshl_add_u32 v24, v25, 2, v24
    v_lshl_add_u32 v24, v15, 3, v24
    v_lshl_add_u32 v24, v24, 2, v19
    v_lshlrev_b32 v25, 2, v15
    v_lshlrev_b32 v26, 1, v15
    v_cmp_gt_u32 vcc, 2, v16
    s_nop 1
    v_cndmask_b32 v25, v26, v25, vcc
    v_lshl_add_u32 v25, v16, 6, v25
    v_lshl_add_u32 v25, v25, 2, v19
    v_mov_b32 v26, 128
    v_cndmask_b32 v26, v26, 8, vcc
    v_add_u32 v26, v26, v25
    v_lshl_add_u32 v27, v16, 6, v15
    v_lshl_add_u32 v27, v27, 2, v19
    v_add_u32 v27, 2048, v27
    v_min_u32 v28, 167, v0
    v_lshlrev_b32 v28, 4, v28
    v_add_u32 v29, 71808, v28
    v_add_u32 v28, 67072, v28
    s_and_b32 s14, s2, 15
    s_lshl_b32 s14, s14, 7
    s_add_u32 s14, s14, 0x99000
    v_lshl_add_u32 v30, v15, 11, s14
    s_mov_b32 m0, s25
    s_waitcnt vmcnt(13)
    s_cmp_lt_u32 s40, 2
    s_cbranch_scc1 p1_wp_5
    s_waitcnt vmcnt(12)
p1_wp_5:
    s_mov_b32 s24, 0x3fb8aa3b
    v_mul_f32 v52, s24, v10
    v_fma_f32 v53, v10, s24, -v52
    v_fmac_f32 v53, 0x32a57060, v10
    v_exp_f32 v52, v52
    v_mul_f32 v53, 0x3f317218, v53
    v_fmac_f32 v52, v52, v53
    v_cvt_pk_bf16_f32 v52, v52, v52
    v_and_b32 v52, 0xffff0000, v52
    v_mul_f32 v54, v52, v4
    v_mul_f32 v55, v52, v5
    v_mul_f32 v54, s24, v54
    v_mul_f32 v55, 0.15915494, v55
    v_mul_f32 v56, 0x3f800000, v54
    v_mul_f32 v57, 0x3f800000, v55
    v_fract_f32 v57, v57
    v_exp_f32 v56, v56
    v_cos_f32 v58, v57
    v_sin_f32 v59, v57
    s_nop 0
    v_pk_mul_f32 v[62:63], v[58:59], v[56:57] op_sel_hi:[1,0]
    v_cvt_pk_bf16_f32 v100, v62, v63
    ds_write_addtid_b32 v100 offset:272
    v_mul_f32 v56, 0x41000000, v54
    v_mul_f32 v57, 0x41000000, v55
    v_fract_f32 v57, v57
    v_exp_f32 v56, v56
    v_cos_f32 v58, v57
    v_sin_f32 v59, v57
    s_nop 0
    v_pk_mul_f32 v[76:77], v[58:59], v[56:57] op_sel_hi:[1,0]
    v_mul_f32 v56, 0x43000000, v54
    v_mul_f32 v57, 0x43000000, v55
    v_fract_f32 v57, v57
    v_exp_f32 v56, v56
    v_cos_f32 v58, v57
    v_sin_f32 v59, v57
    s_nop 0
    v_pk_mul_f32 v[78:79], v[58:59], v[56:57] op_sel_hi:[1,0]
    v_cvt_pk_bf16_f32 v101, v78, v79
    ds_write_addtid_b32 v101 offset:2176
    v_pk_mul_f32 v[64:65], v[62:63], v[62:63] op_sel:[0,0] op_sel_hi:[0,1]
    v_pk_fma_f32 v[64:65], v[62:63], v[62:63], v[64:65] op_sel:[1,1,0] op_sel_hi:[1,0,1] neg_lo:[1,0,0]
    v_cvt_pk_bf16_f32 v102, v64, v65
    ds_write_addtid_b32 v102 offset:544
    v_pk_mul_f32 v[80:81], v[78:79], v[78:79] op_sel:[0,0] op_sel_hi:[0,1]
    v_pk_fma_f32 v[80:81], v[78:79], v[78:79], v[80:81] op_sel:[1,1,0] op_sel_hi:[1,0,1] neg_lo:[1,0,0]
    v_pk_mul_f32 v[66:67], v[64:65], v[62:63] op_sel:[0,0] op_sel_hi:[0,1]
    v_pk_fma_f32 v[66:67], v[64:65], v[62:63], v[66:67] op_sel:[1,1,0] op_sel_hi:[1,0,1] neg_lo:[1,0,0]
    v_cvt_pk_bf16_f32 v103, v66, v67
    ds_write_addtid_b32 v103 offset:816
    v_pk_mul_f32 v[68:69], v[64:65], v[64:65] op_sel:[0,0] op_sel_hi:[0,1]
    v_pk_fma_f32 v[68:69], v[64:65], v[64:65], v[68:69] op_sel:[1,1,0] op_sel_hi:[1,0,1] neg_lo:[1,0,0]
    v_cvt_pk_bf16_f32 v100, v68, v69
    ds_write_addtid_b32 v100 offset:1088
    v_pk_mul_f32 v[70:71], v[68:69], v[62:63] op_sel:[0,0] op_sel_hi:[0,1]
    v_pk_fma_f32 v[70:71], v[68:69], v[62:63], v[70:71] op_sel:[1,1,0] op_sel_hi:[1,0,1] neg_lo:[1,0,0]
    v_cvt_pk_bf16_f32 v101, v70, v71
    ds_write_addtid_b32 v101 offset:1360
    v_pk_mul_f32 v[72:73], v[66:67], v[66:67] op_sel:[0,0] op_sel_hi:[0,1]
    v_pk_fma_f32 v[72:73], v[66:67], v[66:67], v[72:73] op_sel:[1,1,0] op_sel_hi:[1,0,1] neg_lo:[1,0,0]
    v_cvt_pk_bf16_f32 v102, v72, v73
    ds_write_addtid_b32 v102 offset:1632
    v_pk_mul_f32 v[74:75], v[68:69], v[66:67] op_sel:[0,0] op_sel_hi:[0,1]
    v_pk_fma_f32 v[74:75], v[68:69], v[66:67], v[74:75] op_sel:[1,1,0] op_sel_hi:[1,0,1] neg_lo:[1,0,0]
    v_cvt_pk_bf16_f32 v103, v74, v75
    ds_write_addtid_b32 v103 offset:1904
    s_waitcnt vmcnt(9)
    s_cmp_lt_u32 s40, 2
    s_cbranch_scc1 p1_wp_6
    s_waitcnt vmcnt(8)
p1_wp_6:
    v_pk_mul_f32 v[6:7], v[6:7], v[52:53] op_sel_hi:[1,0]
    v_pk_mul_f32 v[84:85], v[8:9], v[6:7] op_sel:[0,0] op_sel_hi:[0,1]
    v_pk_fma_f32 v[84:85], v[8:9], v[6:7], v[84:85] op_sel:[1,1,0] op_sel_hi:[1,0,1] neg_lo:[1,0,0]
    v_cvt_pk_bf16_f32 v100, v84, -v85
    ds_write_addtid_b32 v100 offset:11152
    v_pk_mul_f32 v[86:87], v[84:85], v[76:77] op_sel:[0,0] op_sel_hi:[0,1]
    v_pk_fma_f32 v[86:87], v[84:85], v[76:77], v[86:87] op_sel:[1,1,0] op_sel_hi:[1,0,1] neg_lo:[1,0,0]
    v_cvt_pk_bf16_f32 v101, v86, -v87
    ds_write_addtid_b32 v101 offset:11424
    v_pk_mul_f32 v[82:83], v[80:81], v[78:79] op_sel:[0,0] op_sel_hi:[0,1]
    v_pk_fma_f32 v[82:83], v[80:81], v[78:79], v[82:83] op_sel:[1,1,0] op_sel_hi:[1,0,1] neg_lo:[1,0,0]
    v_cvt_pk_bf16_f32 v102, v80, v81
    ds_write_addtid_b32 v102 offset:4352
    v_pk_mul_f32 v[90:91], v[80:81], v[64:65] op_sel:[0,0] op_sel_hi:[0,1]
    v_pk_fma_f32 v[90:91], v[80:81], v[64:65], v[90:91] op_sel:[1,1,0] op_sel_hi:[1,0,1] neg_lo:[1,0,0]
    v_cvt_pk_bf16_f32 v103, v90, v91
    ds_write_addtid_b32 v103 offset:4624
    v_pk_mul_f32 v[88:89], v[80:81], v[68:69] op_sel:[0,0] op_sel_hi:[0,1]
    v_pk_fma_f32 v[88:89], v[80:81], v[68:69], v[88:89] op_sel:[1,1,0] op_sel_hi:[1,0,1] neg_lo:[1,0,0]
    v_cvt_pk_bf16_f32 v100, v88, v89
    ds_write_addtid_b32 v100 offset:4896
    v_pk_mul_f32 v[90:91], v[80:81], v[72:73] op_sel:[0,0] op_sel_hi:[0,1]
    v_pk_fma_f32 v[90:91], v[80:81], v[72:73], v[90:91] op_sel:[1,1,0] op_sel_hi:[1,0,1] neg_lo:[1,0,0]
    v_cvt_pk_bf16_f32 v101, v90, v91
    ds_write_addtid_b32 v101 offset:5168
    v_pk_mul_f32 v[84:85], v[86:87], v[76:77] op_sel:[0,0] op_sel_hi:[0,1]
    v_pk_fma_f32 v[84:85], v[86:87], v[76:77], v[84:85] op_sel:[1,1,0] op_sel_hi:[1,0,1] neg_lo:[1,0,0]
    v_cvt_pk_bf16_f32 v102, v84, -v85
    ds_write_addtid_b32 v102 offset:11696
    v_pk_mul_f32 v[80:81], v[82:83], v[78:79] op_sel:[0,0] op_sel_hi:[0,1]
    v_pk_fma_f32 v[80:81], v[82:83], v[78:79], v[80:81] op_sel:[1,1,0] op_sel_hi:[1,0,1] neg_lo:[1,0,0]
    v_cvt_pk_bf16_f32 v103, v82, v83
    ds_write_addtid_b32 v103 offset:5440
    v_pk_mul_f32 v[90:91], v[82:83], v[64:65] op_sel:[0,0] op_sel_hi:[0,1]
    v_pk_fma_f32 v[90:91], v[82:83], v[64:65], v[90:91] op_sel:[1,1,0] op_sel_hi:[1,0,1] neg_lo:[1,0,0]
    v_cvt_pk_bf16_f32 v100, v90, v91
    ds_write_addtid_b32 v100 offset:5712
    v_pk_mul_f32 v[88:89], v[82:83], v[68:69] op_sel:[0,0] op_sel_hi:[0,1]
    v_pk_fma_f32 v[88:89], v[82:83], v[68:69], v[88:89] op_sel:[1,1,0] op_sel_hi:[1,0,1] neg_lo:[1,0,0]
    v_cvt_pk_bf16_f32 v101, v88, v89
    ds_write_addtid_b32 v101 offset:5984
    v_pk_mul_f32 v[90:91], v[82:83], v[72:73] op_sel:[0,0] op_sel_hi:[0,1]
    v_pk_fma_f32 v[90:91], v[82:83], v[72:73], v[90:91] op_sel:[1,1,0] op_sel_hi:[1,0,1] neg_lo:[1,0,0]
    v_cvt_pk_bf16_f32 v102, v90, v91
    ds_write_addtid_b32 v102 offset:6256
    v_pk_mul_f32 v[86:87], v[84:85], v[76:77] op_sel:[0,0] op_sel_hi:[0,1]
    v_pk_fma_f32 v[86:87], v[84:85], v[76:77], v[86:87] op_sel:[1,1,0] op_sel_hi:[1,0,1] neg_lo:[1,0,0]
    v_cvt_pk_bf16_f32 v103, v86, -v87
    ds_write_addtid_b32 v103 offset:11968
    v_pk_mul_f32 v[82:83], v[80:81], v[78:79] op_sel:[0,0] op_sel_hi:[0,1]
    v_pk_fma_f32 v[82:83], v[80:81], v[78:79], v[82:83] op_sel:[1,1,0] op_sel_hi:[1,0,1] neg_lo:[1,0,0]
    v_cvt_pk_bf16_f32 v100, v80, v81
    ds_write_addtid_b32 v100 offset:6528
    v_pk_mul_f32 v[90:91], v[80:81], v[68:69] op_sel:[0,0] op_sel_hi:[0,1]
    v_pk_fma_f32 v[90:91], v[80:81], v[68:69], v[90:91] op_sel:[1,1,0] op_sel_hi:[1,0,1] neg_lo:[1,0,0]
    v_cvt_pk_bf16_f32 v101, v90, v91
    ds_write_addtid_b32 v101 offset:6800
    v_pk_mul_f32 v[84:85], v[86:87], v[76:77] op_sel:[0,0] op_sel_hi:[0,1]
    v_pk_fma_f32 v[84:85], v[86:87], v[76:77], v[84:85] op_sel:[1,1,0] op_sel_hi:[1,0,1] neg_lo:[1,0,0]
    v_cvt_pk_bf16_f32 v102, v84, -v85
    ds_write_addtid_b32 v102 offset:12240
    v_pk_mul_f32 v[80:81], v[82:83], v[78:79] op_sel:[0,0] op_sel_hi:[0,1]
    v_pk_fma_f32 v[80:81], v[82:83], v[78:79], v[80:81] op_sel:[1,1,0] op_sel_hi:[1,0,1] neg_lo:[1,0,0]
    v_cvt_pk_bf16_f32 v103, v82, v83
    ds_write_addtid_b32 v103 offset:7072
    v_pk_mul_f32 v[90:91], v[82:83], v[68:69] op_sel:[0,0] op_sel_hi:[0,1]
    v_pk_fma_f32 v[90:91], v[82:83], v[68:69], v[90:91] op_sel:[1,1,0] op_sel_hi:[1,0,1] neg_lo:[1,0,0]
    v_cvt_pk_bf16_f32 v100, v90, v91
    ds_write_addtid_b32 v100 offset:7344
    v_pk_mul_f32 v[86:87], v[84:85], v[76:77] op_sel:[0,0] op_sel_hi:[0,1]
    v_pk_fma_f32 v[86:87], v[84:85], v[76:77], v[86:87] op_sel:[1,1,0] op_sel_hi:[1,0,1] neg_lo:[1,0,0]
    v_cvt_pk_bf16_f32 v101, v86, -v87
    ds_write_addtid_b32 v101 offset:12512
    v_pk_mul_f32 v[82:83], v[80:81], v[78:79] op_sel:[0,0] op_sel_hi:[0,1]
    v_pk_fma_f32 v[82:83], v[80:81], v[78:79], v[82:83] op_sel:[1,1,0] op_sel_hi:[1,0,1] neg_lo:[1,0,0]
    v_cvt_pk_bf16_f32 v102, v80, v81
    ds_write_addtid_b32 v102 offset:7616
    v_pk_mul_f32 v[90:91], v[80:81], v[68:69] op_sel:[0,0] op_sel_hi:[0,1]
    v_pk_fma_f32 v[90:91], v[80:81], v[68:69], v[90:91] op_sel:[1,1,0] op_sel_hi:[1,0,1] neg_lo:[1,0,0]
    v_cvt_pk_bf16_f32 v103, v90, v91
    ds_write_addtid_b32 v103 offset:7888
    v_pk_mul_f32 v[84:85], v[86:87], v[76:77] op_sel:[0,0] op_sel_hi:[0,1]
    v_pk_fma_f32 v[84:85], v[86:87], v[76:77], v[84:85] op_sel:[1,1,0] op_sel_hi:[1,0,1] neg_lo:[1,0,0]
    v_cvt_pk_bf16_f32 v100, v84, -v85
    ds_write_addtid_b32 v100 offset:12784
    v_pk_mul_f32 v[80:81], v[82:83], v[78:79] op_sel:[0,0] op_sel_hi:[0,1]
    v_pk_fma_f32 v[80:81], v[82:83], v[78:79], v[80:81] op_sel:[1,1,0] op_sel_hi:[1,0,1] neg_lo:[1,0,0]
    v_cvt_pk_bf16_f32 v101, v82, v83
    ds_write_addtid_b32 v101 offset:8160
    v_pk_mul_f32 v[90:91], v[82:83], v[68:69] op_sel:[0,0] op_sel_hi:[0,1]
    v_pk_fma_f32 v[90:91], v[82:83], v[68:69], v[90:91] op_sel:[1,1,0] op_sel_hi:[1,0,1] neg_lo:[1,0,0]
    v_cvt_pk_bf16_f32 v102, v90, v91
    ds_write_addtid_b32 v102 offset:8432
    v_pk_mul_f32 v[86:87], v[84:85], v[76:77] op_sel:[0,0] op_sel_hi:[0,1]
    v_pk_fma_f32 v[86:87], v[84:85], v[76:77], v[86:87] op_sel:[1,1,0] op_sel_hi:[1,0,1] neg_lo:[1,0,0]
    v_cvt_pk_bf16_f32 v103, v86, -v87
    ds_write_addtid_b32 v103 offset:13056
    v_pk_mul_f32 v[82:83], v[80:81], v[78:79] op_sel:[0,0] op_sel_hi:[0,1]
    v_pk_fma_f32 v[82:83], v[80:81], v[78:79], v[82:83] op_sel:[1,1,0] op_sel_hi:[1,0,1] neg_lo:[1,0,0]
    v_cvt_pk_bf16_f32 v100, v80, v81
    ds_write_addtid_b32 v100 offset:8704
    v_pk_mul_f32 v[88:89], v[78:79], v[62:63] op_sel:[0,0] op_sel_hi:[0,1]
    v_pk_fma_f32 v[88:89], v[78:79], v[62:63], v[88:89] op_sel:[1,1,0] op_sel_hi:[1,0,1] neg_lo:[1,0,0]
    v_cvt_pk_bf16_f32 v101, v88, v89
    ds_write_addtid_b32 v101 offset:2448
    v_pk_mul_f32 v[84:85], v[86:87], v[76:77] op_sel:[0,0] op_sel_hi:[0,1]
    v_pk_fma_f32 v[84:85], v[86:87], v[76:77], v[84:85] op_sel:[1,1,0] op_sel_hi:[1,0,1] neg_lo:[1,0,0]
    v_cvt_pk_bf16_f32 v102, v84, -v85
    ds_write_addtid_b32 v102 offset:13328
    v_pk_mul_f32 v[80:81], v[82:83], v[78:79] op_sel:[0,0] op_sel_hi:[0,1]
    v_pk_fma_f32 v[80:81], v[82:83], v[78:79], v[80:81] op_sel:[1,1,0] op_sel_hi:[1,0,1] neg_lo:[1,0,0]
    v_cvt_pk_bf16_f32 v103, v82, v83
    ds_write_addtid_b32 v103 offset:8976
    v_pk_mul_f32 v[88:89], v[78:79], v[64:65] op_sel:[0,0] op_sel_hi:[0,1]
    v_pk_fma_f32 v[88:89], v[78:79], v[64:65], v[88:89] op_sel:[1,1,0] op_sel_hi:[1,0,1] neg_lo:[1,0,0]
    v_cvt_pk_bf16_f32 v100, v88, v89
    ds_write_addtid_b32 v100 offset:2720
    v_pk_mul_f32 v[86:87], v[84:85], v[76:77] op_sel:[0,0] op_sel_hi:[0,1]
    v_pk_fma_f32 v[86:87], v[84:85], v[76:77], v[86:87] op_sel:[1,1,0] op_sel_hi:[1,0,1] neg_lo:[1,0,0]
    v_cvt_pk_bf16_f32 v101, v86, -v87
    ds_write_addtid_b32 v101 offset:13600
    v_pk_mul_f32 v[82:83], v[80:81], v[78:79] op_sel:[0,0] op_sel_hi:[0,1]
    v_pk_fma_f32 v[82:83], v[80:81], v[78:79], v[82:83] op_sel:[1,1,0] op_sel_hi:[1,0,1] neg_lo:[1,0,0]
    v_cvt_pk_bf16_f32 v102, v80, v81
    ds_write_addtid_b32 v102 offset:9248
    v_pk_mul_f32 v[88:89], v[78:79], v[66:67] op_sel:[0,0] op_sel_hi:[0,1]
    v_pk_fma_f32 v[88:89], v[78:79], v[66:67], v[88:89] op_sel:[1,1,0] op_sel_hi:[1,0,1] neg_lo:[1,0,0]
    v_cvt_pk_bf16_f32 v103, v88, v89
    ds_write_addtid_b32 v103 offset:2992
    v_pk_mul_f32 v[84:85], v[86:87], v[76:77] op_sel:[0,0] op_sel_hi:[0,1]
    v_pk_fma_f32 v[84:85], v[86:87], v[76:77], v[84:85] op_sel:[1,1,0] op_sel_hi:[1,0,1] neg_lo:[1,0,0]
    v_cvt_pk_bf16_f32 v100, v84, -v85
    ds_write_addtid_b32 v100 offset:13872
    v_pk_mul_f32 v[80:81], v[82:83], v[78:79] op_sel:[0,0] op_sel_hi:[0,1]
    v_pk_fma_f32 v[80:81], v[82:83], v[78:79], v[80:81] op_sel:[1,1,0] op_sel_hi:[1,0,1] neg_lo:[1,0,0]
    v_cvt_pk_bf16_f32 v101, v82, v83
    ds_write_addtid_b32 v101 offset:9520
    v_pk_mul_f32 v[88:89], v[78:79], v[68:69] op_sel:[0,0] op_sel_hi:[0,1]
    v_pk_fma_f32 v[88:89], v[78:79], v[68:69], v[88:89] op_sel:[1,1,0] op_sel_hi:[1,0,1] neg_lo:[1,0,0]
    v_cvt_pk_bf16_f32 v102, v88, v89
    ds_write_addtid_b32 v102 offset:3264
    s_nop 0
    s_cmp_eq_u32 s9, 3
    s_cbranch_scc1 p1_w_8
    s_cmp_lg_u32 s9, 0
    s_cbranch_scc1 p1_m_7
    s_waitcnt vmcnt(0)
    ds_read_b128 v[168:171], v135 offset:0
    ds_read_b128 v[172:175], v135 offset:64
    ds_read_b128 v[176:179], v135 offset:128
    ds_read_b128 v[180:183], v135 offset:192
    ds_read_b128 v[184:187], v135 offset:256
    ds_read_b128 v[188:191], v135 offset:320
    ds_read_b128 v[192:195], v135 offset:384
    ds_read_b128 v[196:199], v135 offset:448
    s_waitcnt lgkmcnt(7)
    v_mfma_f32_16x16x32_bf16 v[208:211], v[204:207], v[168:171], 0
    v_mfma_f32_16x16x32_bf16 v[212:215], v[168:171], v[168:171], 0
    s_waitcnt lgkmcnt(6)
    v_mfma_f32_16x16x32_bf16 v[208:211], v[204:207], v[172:175], v[208:211]
    v_mfma_f32_16x16x32_bf16 v[212:215], v[172:175], v[172:175], v[212:215]
    s_waitcnt lgkmcnt(5)
    v_mfma_f32_16x16x32_bf16 v[208:211], v[204:207], v[176:179], v[208:211]
    v_mfma_f32_16x16x32_bf16 v[212:215], v[176:179], v[176:179], v[212:215]
    s_waitcnt lgkmcnt(4)
    v_mfma_f32_16x16x32_bf16 v[208:211], v[204:207], v[180:183], v[208:211]
    v_mfma_f32_16x16x32_bf16 v[212:215], v[180:183], v[180:183], v[212:215]
    s_waitcnt lgkmcnt(3)
    v_mfma_f32_16x16x32_bf16 v[208:211], v[204:207], v[184:187], v[208:211]
    v_mfma_f32_16x16x32_bf16 v[212:215], v[184:187], v[184:187], v[212:215]
    s_waitcnt lgkmcnt(2)
    v_mfma_f32_16x16x32_bf16 v[208:211], v[204:207], v[188:191], v[208:211]
    v_mfma_f32_16x16x32_bf16 v[212:215], v[188:191], v[188:191], v[212:215]
    s_waitcnt lgkmcnt(1)
    v_mfma_f32_16x16x32_bf16 v[208:211], v[204:207], v[192:195], v[208:211]
    v_mfma_f32_16x16x32_bf16 v[212:215], v[192:195], v[192:195], v[212:215]
    s_waitcnt lgkmcnt(0)
    v_mfma_f32_16x16x32_bf16 v[208:211], v[204:207], v[196:199], v[208:211]
    v_mfma_f32_16x16x32_bf16 v[212:215], v[196:199], v[196:199], v[212:215]
    v_cmp_eq_u32 vcc, 1, v203
    s_nop 6
    v_cndmask_b32 v212, v212, v213, vcc
    v_cmp_eq_u32 vcc, 2, v203
    s_nop 1
    v_cndmask_b32 v212, v212, v214, vcc
    v_cmp_eq_u32 vcc, 3, v203
    s_nop 1
    v_cndmask_b32 v212, v212, v215, vcc
    ds_bpermute_b32 v212, v202, v212
    v_add_f32_dpp v208, v208, v208 row_ror:8 row_mask:0xf bank_mask:0xf
    s_waitcnt lgkmcnt(0)
    v_add_f32_dpp v212, v212, v212 row_ror:8 row_mask:0xf bank_mask:0xf
    v_mul_f32 v208, 0x3b000000, v208
    v_mul_f32 v212, 0x3b000000, v212
    v_fma_f32 v211, -v208, v208, v212
    v_max_f32 v211, 0, v211
    v_cvt_pk_bf16_f32 v211, v211, v211
    v_and_b32 v211, 0xffff0000, v211
    v_add_f32 v211, 0x3727c5ac, v211
    v_cvt_pk_bf16_f32 v211, v211, v211
    v_and_b32 v211, 0xffff0000, v211
    v_sqrt_f32 v211, v211
    v_cvt_pk_bf16_f32 v209, v208, v208
    v_and_b32 v209, 0xffff0000, v209
    v_cvt_pk_bf16_f32 v211, v211, v211
    v_and_b32 v211, 0xffff0000, v211
    v_rcp_f32 v210, v211
    s_nop 0
    v_mul_f32 v209, v209, v210
    v_sub_f32 v209, 0, v209
    v_cmp_gt_u32 vcc, 8, v2
    s_nop 1
    v_cndmask_b32 v210, v209, v210, vcc
    s_mov_b64 exec, 0xffff
    global_store_dword v133, v210, s[4:5] sc1
    s_mov_b64 exec, -1
    s_branch p1_helped0
p1_m_7:
    s_branch p1_helped0
p1_w_8:
    s_waitcnt vmcnt(0)
    v_perm_b32 v168, v140, v136, s36
    v_perm_b32 v169, v148, v144, s36
    v_perm_b32 v170, v156, v152, s36
    v_perm_b32 v171, v164, v160, s36
    global_store_dwordx4 v133, v[168:171], s[4:5] sc1
    v_add_u32 v133, 4096, v133
    v_perm_b32 v172, v140, v136, s37
    v_perm_b32 v173, v148, v144, s37
    v_perm_b32 v174, v156, v152, s37
    v_perm_b32 v175, v164, v160, s37
    global_store_dwordx4 v133, v[172:175], s[4:5] sc1
    v_add_u32 v133, 4096, v133
    v_perm_b32 v176, v141, v137, s36
    v_perm_b32 v177, v149, v145, s36
    v_perm_b32 v178, v157, v153, s36
    v_perm_b32 v179, v165, v161, s36
    global_store_dwordx4 v133, v[176:179], s[4:5] sc1
    v_add_u32 v133, 4096, v133
    v_perm_b32 v180, v141, v137, s37
    v_perm_b32 v181, v149, v145, s37
    v_perm_b32 v182, v157, v153, s37
    v_perm_b32 v183, v165, v161, s37
    global_store_dwordx4 v133, v[180:183], s[4:5] sc1
    v_add_u32 v133, 4096, v133
    v_perm_b32 v184, v142, v138, s36
    v_perm_b32 v185, v150, v146, s36
    v_perm_b32 v186, v158, v154, s36
    v_perm_b32 v187, v166, v162, s36
    global_store_dwordx4 v133, v[184:187], s[4:5] sc1
    v_add_u32 v133, 4096, v133
    v_perm_b32 v188, v142, v138, s37
    v_perm_b32 v189, v150, v146, s37
    v_perm_b32 v190, v158, v154, s37
    v_perm_b32 v191, v166, v162, s37
    global_store_dwordx4 v133, v[188:191], s[4:5] sc1
    v_add_u32 v133, 4096, v133
    v_perm_b32 v192, v143, v139, s36
    v_perm_b32 v193, v151, v147, s36
    v_perm_b32 v194, v159, v155, s36
    v_perm_b32 v195, v167, v163, s36
    global_store_dwordx4 v133, v[192:195], s[4:5] sc1
    v_add_u32 v133, 4096, v133
    v_perm_b32 v196, v143, v139, s37
    v_perm_b32 v197, v151, v147, s37
    v_perm_b32 v198, v159, v155, s37
    v_perm_b32 v199, v167, v163, s37
    global_store_dwordx4 v133, v[196:199], s[4:5] sc1
    s_nop 1
p1_helped0:
    s_cmp_eq_u32 s9, 3
    s_cbranch_scc1 p1_w_10
    s_cmp_lg_u32 s9, 0
    s_cbranch_scc1 p1_m_9
    s_branch p1_helped
p1_m_9:
    s_cmp_ge_u32 s2, 192
    s_cbranch_scc1 p1_helped
    s_waitcnt vmcnt(8)
    v_lshlrev_b32 v138, 16, v136
    v_and_b32 v139, 0xffff0000, v136
    v_mul_f32 v140, 0xbfb8aa3b, v138
    v_mul_f32 v141, 0xbfb8aa3b, v139
    v_exp_f32 v140, v140
    v_exp_f32 v141, v141
    v_add_f32 v140, 1.0, v140
    v_add_f32 v141, 1.0, v141
    v_rcp_f32 v140, v140
    v_rcp_f32 v141, v141
    v_mul_f32 v138, v138, v140
    v_mul_f32 v139, v139, v141
    v_cvt_pk_bf16_f32 v138, v138, v139
    ds_write_b32 v135, v138 offset:8192
    ds_read_b128 v[144:147], v201 offset:8192
    ds_read_b128 v[148:151], v201 offset:8256
    ds_read_b128 v[152:155], v201 offset:8320
    ds_read_b128 v[156:159], v201 offset:8384
    s_waitcnt vmcnt(6)
    ds_read_b64_tr_b16 v[160:161], v134 offset:0
    ds_read_b64_tr_b16 v[162:163], v134 offset:256
    ds_read_b64_tr_b16 v[164:165], v134 offset:32
    ds_read_b64_tr_b16 v[166:167], v134 offset:288
    s_waitcnt vmcnt(4)
    ds_read_b64_tr_b16 v[168:169], v134 offset:2048
    ds_read_b64_tr_b16 v[170:171], v134 offset:2304
    ds_read_b64_tr_b16 v[172:173], v134 offset:2080
    ds_read_b64_tr_b16 v[174:175], v134 offset:2336
    s_waitcnt vmcnt(2)
    ds_read_b64_tr_b16 v[176:177], v134 offset:4096
    ds_read_b64_tr_b16 v[178:179], v134 offset:4352
    ds_read_b64_tr_b16 v[180:181], v134 offset:4128
    ds_read_b64_tr_b16 v[182:183], v134 offset:4384
    s_waitcnt vmcnt(0)
    ds_read_b64_tr_b16 v[184:185], v134 offset:6144
    ds_read_b64_tr_b16 v[186:187], v134 offset:6400
    ds_read_b64_tr_b16 v[188:189], v134 offset:6176
    ds_read_b64_tr_b16 v[190:191], v134 offset:6432
    v_cmp_gt_u32 vcc, 16, v2
    s_waitcnt lgkmcnt(12)
    v_mfma_f32_16x16x32_bf16 v[192:195], v[144:147], v[160:163], 0
    v_mfma_f32_16x16x32_bf16 v[196:199], v[144:147], v[164:167], 0
    s_waitcnt lgkmcnt(8)
    v_mfma_f32_16x16x32_bf16 v[192:195], v[148:151], v[168:171], v[192:195]
    v_mfma_f32_16x16x32_bf16 v[196:199], v[148:151], v[172:175], v[196:199]
    s_waitcnt lgkmcnt(4)
    v_mfma_f32_16x16x32_bf16 v[192:195], v[152:155], v[176:179], v[192:195]
    v_mfma_f32_16x16x32_bf16 v[196:199], v[152:155], v[180:183], v[196:199]
    s_waitcnt lgkmcnt(0)
    v_mfma_f32_16x16x32_bf16 v[192:195], v[156:159], v[184:187], v[192:195]
    v_mfma_f32_16x16x32_bf16 v[196:199], v[156:159], v[188:191], v[196:199]
    s_nop 7
    v_cndmask_b32 v192, v196, v192, vcc
    s_mov_b32 exec_hi, 0
    global_store_dword v200, v192, s[4:5] sc1
    s_mov_b64 exec, -1
    s_branch p1_helped
p1_w_10:
p1_helped:
    global_load_dword v34, v31, s[94:95] sc1
    v_pk_mul_f32 v[86:87], v[84:85], v[76:77] op_sel:[0,0] op_sel_hi:[0,1]
    v_pk_fma_f32 v[86:87], v[84:85], v[76:77], v[86:87] op_sel:[1,1,0] op_sel_hi:[1,0,1] neg_lo:[1,0,0]
    v_cvt_pk_bf16_f32 v103, v86, -v87
    ds_write_addtid_b32 v103 offset:14144
    v_pk_mul_f32 v[82:83], v[80:81], v[78:79] op_sel:[0,0] op_sel_hi:[0,1]
    v_pk_fma_f32 v[82:83], v[80:81], v[78:79], v[82:83] op_sel:[1,1,0] op_sel_hi:[1,0,1] neg_lo:[1,0,0]
    v_cvt_pk_bf16_f32 v100, v80, v81
    ds_write_addtid_b32 v100 offset:9792
    v_pk_mul_f32 v[88:89], v[78:79], v[70:71] op_sel:[0,0] op_sel_hi:[0,1]
    v_pk_fma_f32 v[88:89], v[78:79], v[70:71], v[88:89] op_sel:[1,1,0] op_sel_hi:[1,0,1] neg_lo:[1,0,0]
    v_cvt_pk_bf16_f32 v101, v88, v89
    ds_write_addtid_b32 v101 offset:3536
    v_pk_mul_f32 v[84:85], v[86:87], v[76:77] op_sel:[0,0] op_sel_hi:[0,1]
    v_pk_fma_f32 v[84:85], v[86:87], v[76:77], v[84:85] op_sel:[1,1,0] op_sel_hi:[1,0,1] neg_lo:[1,0,0]
    v_cvt_pk_bf16_f32 v102, v84, -v85
    ds_write_addtid_b32 v102 offset:14416
    v_pk_mul_f32 v[80:81], v[82:83], v[78:79] op_sel:[0,0] op_sel_hi:[0,1]
    v_pk_fma_f32 v[80:81], v[82:83], v[78:79], v[80:81] op_sel:[1,1,0] op_sel_hi:[1,0,1] neg_lo:[1,0,0]
    v_cvt_pk_bf16_f32 v103, v82, v83
    ds_write_addtid_b32 v103 offset:10064
    v_pk_mul_f32 v[88:89], v[78:79], v[72:73] op_sel:[0,0] op_sel_hi:[0,1]
    v_pk_fma_f32 v[88:89], v[78:79], v[72:73], v[88:89] op_sel:[1,1,0] op_sel_hi:[1,0,1] neg_lo:[1,0,0]
    v_cvt_pk_bf16_f32 v100, v88, v89
    ds_write_addtid_b32 v100 offset:3808
    v_pk_mul_f32 v[86:87], v[84:85], v[76:77] op_sel:[0,0] op_sel_hi:[0,1]
    v_pk_fma_f32 v[86:87], v[84:85], v[76:77], v[86:87] op_sel:[1,1,0] op_sel_hi:[1,0,1] neg_lo:[1,0,0]
    v_cvt_pk_bf16_f32 v101, v86, -v87
    ds_write_addtid_b32 v101 offset:14688
    v_pk_mul_f32 v[82:83], v[80:81], v[78:79] op_sel:[0,0] op_sel_hi:[0,1]
    v_pk_fma_f32 v[82:83], v[80:81], v[78:79], v[82:83] op_sel:[1,1,0] op_sel_hi:[1,0,1] neg_lo:[1,0,0]
    v_cvt_pk_bf16_f32 v102, v80, v81
    ds_write_addtid_b32 v102 offset:10336
    v_pk_mul_f32 v[88:89], v[78:79], v[74:75] op_sel:[0,0] op_sel_hi:[0,1]
    v_pk_fma_f32 v[88:89], v[78:79], v[74:75], v[88:89] op_sel:[1,1,0] op_sel_hi:[1,0,1] neg_lo:[1,0,0]
    v_cvt_pk_bf16_f32 v103, v88, v89
    ds_write_addtid_b32 v103 offset:4080
    v_lshlrev_b32 v48, 3, v0
    v_sub_u32 v48, 2047, v48
    v_cvt_f32_i32 v49, v48
    s_movk_i32 s26, 0x4280
    s_mov_b32 s27, 67072
    v_subrev_f32 v50, 0x00000000, v49
    v_subrev_f32 v51, 0x3f800000, v49
    v_cvt_pk_bf16_f32 v51, v50, v51
    v_and_b32 v37, 0xffff, v51
    v_subrev_u32 v37, s26, v37
    v_subrev_u32 v50, 0, v48
    v_min_i32 v50, 128, v50
    v_max_i32 v37, v50, v37
    v_lshl_add_u32 v37, v37, 2, s27
    v_lshrrev_b32 v38, 16, v51
    v_subrev_u32 v38, s26, v38
    v_subrev_u32 v50, 1, v48
    v_min_i32 v50, 128, v50
    v_max_i32 v38, v50, v38
    v_lshl_add_u32 v38, v38, 2, s27
    v_subrev_f32 v50, 0x40000000, v49
    v_subrev_f32 v51, 0x40400000, v49
    v_cvt_pk_bf16_f32 v51, v50, v51
    v_and_b32 v39, 0xffff, v51
    v_subrev_u32 v39, s26, v39
    v_subrev_u32 v50, 2, v48
    v_min_i32 v50, 128, v50
    v_max_i32 v39, v50, v39
    v_lshl_add_u32 v39, v39, 2, s27
    v_lshrrev_b32 v40, 16, v51
    v_subrev_u32 v40, s26, v40
    v_subrev_u32 v50, 3, v48
    v_min_i32 v50, 128, v50
    v_max_i32 v40, v50, v40
    v_lshl_add_u32 v40, v40, 2, s27
    v_subrev_f32 v50, 0x40800000, v49
    v_subrev_f32 v51, 0x40a00000, v49
    v_cvt_pk_bf16_f32 v51, v50, v51
    v_and_b32 v41, 0xffff, v51
    v_subrev_u32 v41, s26, v41
    v_subrev_u32 v50, 4, v48
    v_min_i32 v50, 128, v50
    v_max_i32 v41, v50, v41
    v_lshl_add_u32 v41, v41, 2, s27
    v_lshrrev_b32 v42, 16, v51
    v_subrev_u32 v42, s26, v42
    v_subrev_u32 v50, 5, v48
    v_min_i32 v50, 128, v50
    v_max_i32 v42, v50, v42
    v_lshl_add_u32 v42, v42, 2, s27
    v_subrev_f32 v50, 0x40c00000, v49
    v_subrev_f32 v51, 0x40e00000, v49
    v_cvt_pk_bf16_f32 v51, v50, v51
    v_and_b32 v43, 0xffff, v51
    v_subrev_u32 v43, s26, v43
    v_subrev_u32 v50, 6, v48
    v_min_i32 v50, 128, v50
    v_max_i32 v43, v50, v43
    v_lshl_add_u32 v43, v43, 2, s27
    v_lshrrev_b32 v44, 16, v51
    v_subrev_u32 v44, s26, v44
    v_subrev_u32 v50, 7, v48
    v_min_i32 v50, 128, v50
    v_max_i32 v44, v50, v44
    v_lshl_add_u32 v44, v44, 2, s27
    v_subrev_f32 v50, 0x41000000, v49
    v_subrev_f32 v51, 0x41100000, v49
    v_cvt_pk_bf16_f32 v51, v50, v51
    v_and_b32 v45, 0xffff, v51
    v_subrev_u32 v45, s26, v45
    v_subrev_u32 v50, 8, v48
    v_min_i32 v50, 128, v50
    v_max_i32 v45, v50, v45
    v_min_u32 v45, 648, v45
    v_lshl_add_u32 v45, v45, 2, s27
    v_lshrrev_b32 v46, 16, v51
    v_subrev_u32 v46, s26, v46
    v_subrev_u32 v50, 9, v48
    v_min_i32 v50, 128, v50
    v_max_i32 v46, v50, v46
    v_min_u32 v46, 648, v46
    v_lshl_add_u32 v46, v46, 2, s27
    v_subrev_f32 v50, 0x41200000, v49
    v_subrev_f32 v51, 0x41300000, v49
    v_cvt_pk_bf16_f32 v51, v50, v51
    v_and_b32 v47, 0xffff, v51
    v_subrev_u32 v47, s26, v47
    v_subrev_u32 v50, 10, v48
    v_min_i32 v50, 128, v50
    v_max_i32 v47, v50, v47
    v_min_u32 v47, 648, v47
    v_lshl_add_u32 v47, v47, 2, s27
    s_waitcnt vmcnt(0)
    s_mov_b64 exec, 1
    ds_add_rtn_u32 v36, v35, v32
    s_mov_b64 exec, -1
    s_waitcnt lgkmcnt(0)
    v_readfirstlane_b32 s15, v36
    s_nop 1
    s_cmp_lg_u32 s15, 3
    s_cbranch_scc1 p1_ns
    s_mov_b32 s14, 200000
sp_l_12:
    v_cmp_gt_u32 vcc, 8, v34
    s_nop 1
    s_cmp_eq_u64 vcc, 0
    s_cbranch_scc1 sp_go_11
    s_sleep 1
    global_load_dword v34, v31, s[94:95] sc1
    s_sub_u32 s14, s14, 1
    s_cmp_lg_u32 s14, 0
    s_waitcnt vmcnt(0)
    s_cbranch_scc1 sp_l_12
sp_go_11:
    s_mov_b64 exec, 0xffff
    global_atomic_add v30, v32, s[4:5] sc1
    s_mov_b64 exec, -1
p1_ns:
    v_pk_mul_f32 v[84:85], v[86:87], v[76:77] op_sel:[0,0] op_sel_hi:[0,1]
    v_pk_fma_f32 v[84:85], v[86:87], v[76:77], v[84:85] op_sel:[1,1,0] op_sel_hi:[1,0,1] neg_lo:[1,0,0]
    v_cvt_pk_bf16_f32 v100, v84, -v85
    ds_write_addtid_b32 v100 offset:14960
    v_pk_mul_f32 v[80:81], v[82:83], v[78:79] op_sel:[0,0] op_sel_hi:[0,1]
    v_pk_fma_f32 v[80:81], v[82:83], v[78:79], v[80:81] op_sel:[1,1,0] op_sel_hi:[1,0,1] neg_lo:[1,0,0]
    v_cvt_pk_bf16_f32 v101, v82, v83
    ds_write_addtid_b32 v101 offset:10608
    v_pk_mul_f32 v[86:87], v[84:85], v[76:77] op_sel:[0,0] op_sel_hi:[0,1]
    v_pk_fma_f32 v[86:87], v[84:85], v[76:77], v[86:87] op_sel:[1,1,0] op_sel_hi:[1,0,1] neg_lo:[1,0,0]
    v_cvt_pk_bf16_f32 v102, v86, -v87
    ds_write_addtid_b32 v102 offset:15232
    v_cvt_pk_bf16_f32 v103, v80, v81
    ds_write_addtid_b32 v103 offset:10880
    s_waitcnt lgkmcnt(0)
    ds_read_b128 v[60:63], v17 offset:11152
    ds_read_b128 v[64:67], v17 offset:11216
    ds_read_b128 v[68:71], v17 offset:11280
    ds_read_b128 v[72:75], v17 offset:11344
    ds_read_b128 v[76:79], v17 offset:0
    ds_read_b128 v[80:83], v17 offset:64
    ds_read_b128 v[84:87], v17 offset:128
    ds_read_b128 v[88:91], v17 offset:192
    ds_read_b128 v[92:95], v17 offset:4352
    ds_read_b128 v[96:99], v17 offset:4416
    ds_read_b128 v[100:103], v17 offset:4480
    ds_read_b128 v[104:107], v17 offset:4544
    ds_read_b128 v[108:111], v17 offset:8704
    ds_read_b128 v[112:115], v17 offset:8768
    ds_read_b128 v[116:119], v17 offset:8832
    ds_read_b128 v[120:123], v17 offset:8896
    s_and_b32 s3, s2, 7
    s_lshr_b32 s8, s2, 3
    s_lshl_b32 s19, s8, 4
    s_add_u32 s19, s19, s3
    s_lshr_b32 s10, s9, 1
    s_and_b32 s11, s9, 1
    s_lshl_b32 s12, s10, 3
    s_add_u32 s12, s12, s19
    s_lshl_b32 s21, s12, 1
    v_mov_b32 v179, s21
    v_mov_b32 v9, 0
    s_min_u32 s28, s8, 27
    s_and_b32 s29, s3, 1
    s_mul_i32 s29, s29, 28
    s_add_u32 s28, s28, s29
    s_lshr_b32 s29, s3, 1
    s_lshl_b32 s30, s29, 2
    s_add_u32 s30, s30, s9
    s_mul_i32 s31, s30, 114688
    s_lshl_b32 s32, s28, 6
    s_add_u32 s31, s31, s32
    v_lshrrev_b32 v176, 4, v2
    v_mul_u32_u24 v176, 28672, v176
    v_and_b32 v177, 15, v2
    v_lshl_add_u32 v176, v177, 2, v176
    v_add_u32 v176, s31, v176
    global_load_short_d16_hi v9, v179, s[80:81]
    global_load_dword v184, v176, s[84:85] offset:0
    global_load_dword v185, v176, s[84:85] offset:3584
    v_add_u32 v176, 7168, v176
    global_load_dword v186, v176, s[84:85] offset:0
    global_load_dword v187, v176, s[84:85] offset:3584
    v_add_u32 v176, 7168, v176
    global_load_dword v188, v176, s[84:85] offset:0
    global_load_dword v189, v176, s[84:85] offset:3584
    v_add_u32 v176, 7168, v176
    global_load_dword v190, v176, s[84:85] offset:0
    global_load_dword v191, v176, s[84:85] offset:3584
    s_min_u32 s61, s2, 223
    s_and_b32 s62, s61, 3
    s_lshl_b32 s62, s62, 2
    s_add_u32 s62, s62, s9
    s_lshr_b32 s61, s61, 2
    s_mul_i32 s57, s61, 9363
    s_lshr_b32 s57, s57, 16
    s_mul_i32 s58, s57, 7
    s_sub_u32 s58, s61, s58
    s_lshl_b32 s59, s58, 1
    s_cmp_ge_u32 s58, 3
    s_addc_u32 s59, s59, 0
    s_cmp_eq_u32 s58, 6
    s_cselect_b32 s59, 6, s59
    s_cselect_b32 s60, 7, 1
    s_mul_i32 s57, s57, 14
    s_add_u32 s59, s59, s57
    s_add_u32 s60, s60, s59
    s_lshl_b32 s58, s62, 6
    s_lshr_b32 s57, s59, 1
    s_lshl_b32 s57, s57, 5
    s_and_b32 s59, s59, 1
    s_add_u32 s59, s59, s57
    s_lshl_b32 s59, s59, 10
    s_add_u32 s59, s59, s58
    s_lshr_b32 s57, s60, 1
    s_lshl_b32 s57, s57, 5
    s_and_b32 s60, s60, 1
    s_add_u32 s60, s60, s57
    s_lshl_b32 s60, s60, 10
    s_add_u32 s60, s60, s58
    v_lshrrev_b32 v251, 4, v2
    v_lshlrev_b32 v251, 13, v251
    v_and_b32 v253, 15, v2
    v_lshl_add_u32 v251, v253, 2, v251
    v_add_u32 v253, s60, v251
    v_add_u32 v251, s59, v251
    global_load_dword v242, v251, s[86:87] offset:0
    global_load_dword v243, v251, s[86:87] offset:2048
    v_add_u32 v251, 4096, v251
    global_load_dword v244, v251, s[86:87] offset:0
    global_load_dword v245, v251, s[86:87] offset:2048
    global_load_dword v246, v253, s[86:87] offset:0
    global_load_dword v247, v253, s[86:87] offset:2048
    v_add_u32 v253, 4096, v253
    global_load_dword v248, v253, s[86:87] offset:0
    global_load_dword v249, v253, s[86:87] offset:2048
    s_lshr_b32 s57, s62, 1
    s_mul_i32 s57, s57, 229376
    s_lshl_b32 s61, s61, 12
    s_add_u32 s61, s61, s57
    s_and_b32 s62, s62, 1
    s_lshl_b32 s62, s62, 11
    s_add_u32 s61, s61, s62
    s_add_u32 s61, s61, 0x900000
    v_lshl_add_u32 v250, v2, 4, s61
    s_waitcnt lgkmcnt(8)
    v_mfma_f32_16x16x32_bf16 v[4:7], v[76:79], v[60:63], 0
    v_mfma_f32_16x16x32_bf16 v[4:7], v[80:83], v[64:67], v[4:7]
    v_mfma_f32_16x16x32_bf16 v[4:7], v[84:87], v[68:71], v[4:7]
    v_mfma_f32_16x16x32_bf16 v[4:7], v[88:91], v[72:75], v[4:7]
    s_waitcnt lgkmcnt(4)
    v_mfma_f32_16x16x32_bf16 v[12:15], v[92:95], v[60:63], 0
    v_mfma_f32_16x16x32_bf16 v[12:15], v[96:99], v[64:67], v[12:15]
    v_mfma_f32_16x16x32_bf16 v[12:15], v[100:103], v[68:71], v[12:15]
    v_mfma_f32_16x16x32_bf16 v[12:15], v[104:107], v[72:75], v[12:15]
    s_waitcnt lgkmcnt(0)
    v_mfma_f32_16x16x32_bf16 v[52:55], v[108:111], v[60:63], 0
    v_mfma_f32_16x16x32_bf16 v[52:55], v[112:115], v[64:67], v[52:55]
    v_mfma_f32_16x16x32_bf16 v[52:55], v[116:119], v[68:71], v[52:55]
    v_mfma_f32_16x16x32_bf16 v[52:55], v[120:123], v[72:75], v[52:55]
    ds_write_b128 v24, v[4:7]
    s_nop 1
    ds_write_b64 v25, v[12:13] offset:1024
    ds_write_b64 v26, v[14:15] offset:1024
    s_nop 2
    ds_write2_b32 v27, v52, v53 offset0:0 offset1:16
    ds_write2_b32 v27, v54, v55 offset0:32 offset1:48
    s_waitcnt lgkmcnt(0)
    s_barrier
    ds_read_b128 v[60:63], v29 offset:0
    ds_read_b128 v[64:67], v29 offset:3088
    ds_read_b128 v[68:71], v29 offset:6176
    ds_read_b128 v[72:75], v29 offset:9264
    v_mov_b32 v54, 67072
    s_mov_b32 s38, 0x05040100
    s_mov_b32 s39, 0x07060302
    v_mov_b32 v56, 0
    v_mov_b32 v57, 0
    v_mov_b32 v58, 0
    v_mov_b32 v59, 0
    v_lshrrev_b32 v12, 5, v0
    v_mul_u32_u24 v12, 4608, v12
    v_and_b32 v13, 31, v0
    v_lshl_add_u32 v12, v13, 4, v12
    v_add_u32 v12, 33280, v12
    v_bfe_u32 v13, v0, 1, 3
    v_mul_u32_u24 v13, 4160, v13
    v_and_b32 v14, 1, v0
    v_lshl_add_u32 v13, v14, 4, v13
    v_add_u32 v13, 4096, v13
    v_cmp_gt_u32 vcc, 64, v0
    s_nop 1
    v_cndmask_b32 v12, v13, v12, vcc
    v_cmp_gt_u32 vcc, 80, v0
    s_nop 1
    s_and_saveexec_b64 s[16:17], vcc
    ds_write_b128 v12, v[56:59]
    s_mov_b64 exec, s[16:17]
    v_lshlrev_b32 v53, 4, v0
    s_waitcnt lgkmcnt(0)
    v_pk_add_f32 v[60:61], v[60:61], v[64:65]
    v_pk_add_f32 v[62:63], v[62:63], v[66:67]
    v_pk_add_f32 v[68:69], v[68:69], v[72:73]
    v_pk_add_f32 v[70:71], v[70:71], v[74:75]
    v_cvt_pk_bf16_f32 v80, v60, v68
    v_cvt_pk_bf16_f32 v81, v61, v69
    v_cvt_pk_bf16_f32 v82, v62, v70
    v_cvt_pk_bf16_f32 v83, v63, v71
    ds_write_b128 v28, v[80:83]
    s_waitcnt lgkmcnt(0)
    s_barrier
    ds_write_b32 v54, v56 offset:2592
    ds_read_b32 v124, v37
    ds_read_b32 v125, v38
    ds_read_b32 v126, v39
    ds_read_b32 v127, v40
    ds_read_b32 v128, v41
    ds_read_b32 v129, v42
    ds_read_b32 v130, v43
    ds_read_b32 v131, v44
    ds_read_b32 v132, v45
    ds_read_b32 v133, v46
    ds_read_b32 v134, v47
    s_lshl_b32 s15, s3, 12
    s_lshl_b32 s13, s8, 7
    s_add_u32 s15, s15, s13
    s_add_u32 s15, s15, 0x100000
    s_lshl_b32 s13, s9, 19
    s_add_u32 s15, s15, s13
    v_lshrrev_b32 v42, 3, v2
    v_lshl_add_u32 v42, v42, 15, s15
    v_and_b32 v41, 7, v2
    v_lshl_add_u32 v42, v41, 4, v42
    v_add_u32 v43, 0x40000, v42
    s_lshl_b32 s20, s9, 11
    s_add_u32 s20, s20, 42496
    v_lshrrev_b32 v41, 4, v2
    v_xor_b32 v6, v41, v2
    s_lshl_b32 s21, s9, 12
    s_add_u32 s13, s21, 0x8000
    v_lshl_add_u32 v6, v6, 4, s13
    s_add_u32 s21, s21, 71808
    v_bfe_u32 v41, v0, 2, 2
    v_lshlrev_b32 v44, 6, v0
    v_lshl_add_u32 v44, v41, 4, v44
    v_add_u32 v44, 71808, v44
    v_xor_b32 v45, 16, v44
    v_xor_b32 v46, 32, v44
    v_xor_b32 v47, 48, v44
    v_lshrrev_b32 v51, 2, v0
    v_lshlrev_b32 v51, 7, v51
    v_and_b32 v41, 3, v0
    v_lshl_add_u32 v51, v41, 4, v51
    s_lshl_b32 s19, s19, 2
    s_add_u32 s19, s19, 0x30000
    v_and_b32 v40, 3, v2
    v_mul_u32_u24 v40, 12288, v40
    v_bfe_u32 v41, v2, 2, 1
    v_lshl_add_u32 v40, v41, 5, v40
    v_bfe_u32 v41, v2, 3, 2
    v_lshl_add_u32 v40, v41, 11, v40
    v_add_u32 v40, s19, v40
    v_and_b32 v177, 31, v2
    v_lshrrev_b32 v178, 5, v2
    v_lshlrev_b32 v178, 11, v178
    v_sub_u32 v178, 204800, v178
    v_lshl_add_u32 v177, v177, 2, v178
    s_lshl_b32 s31, s30, 7
    v_add_u32 v177, s31, v177
    v_and_b32 v12, 15, v0
    v_bfe_u32 v13, v0, 4, 2
    s_lshr_b32 s14, s2, 4
    s_lshl_b32 s14, s14, 11
    s_add_u32 s14, s14, 0x99000
    v_lshl_add_u32 v55, v12, 7, s14
    s_cmp_lg_u32 s9, 1
    s_cbranch_scc1 cv_np0
    global_load_dword v52, v55, s[4:5] sc1
cv_np0:
    s_waitcnt lgkmcnt(0)
    v_perm_b32 v136, v125, v124, s38
    v_perm_b32 v137, v127, v126, s38
    v_perm_b32 v138, v129, v128, s38
    v_perm_b32 v139, v131, v130, s38
    ds_write_b128 v53, v[136:139] offset:0
    v_perm_b32 v140, v126, v125, s38
    v_perm_b32 v141, v128, v127, s38
    v_perm_b32 v142, v130, v129, s38
    v_perm_b32 v143, v132, v131, s38
    ds_write_b128 v53, v[140:143] offset:4160
    v_perm_b32 v144, v127, v126, s38
    v_perm_b32 v145, v129, v128, s38
    v_perm_b32 v146, v131, v130, s38
    v_perm_b32 v147, v133, v132, s38
    ds_write_b128 v53, v[144:147] offset:8320
    v_perm_b32 v148, v128, v127, s38
    v_perm_b32 v149, v130, v129, s38
    v_perm_b32 v150, v132, v131, s38
    v_perm_b32 v151, v134, v133, s38
    ds_write_b128 v53, v[148:151] offset:12480
    v_perm_b32 v136, v125, v124, s39
    v_perm_b32 v137, v127, v126, s39
    v_perm_b32 v138, v129, v128, s39
    v_perm_b32 v139, v131, v130, s39
    ds_write_b128 v53, v[136:139] offset:16640
    v_perm_b32 v140, v126, v125, s39
    v_perm_b32 v141, v128, v127, s39
    v_perm_b32 v142, v130, v129, s39
    v_perm_b32 v143, v132, v131, s39
    ds_write_b128 v53, v[140:143] offset:20800
    v_perm_b32 v144, v127, v126, s39
    v_perm_b32 v145, v129, v128, s39
    v_perm_b32 v146, v131, v130, s39
    v_perm_b32 v147, v133, v132, s39
    ds_write_b128 v53, v[144:147] offset:24960
    v_perm_b32 v148, v128, v127, s39
    v_perm_b32 v149, v130, v129, s39
    v_perm_b32 v150, v132, v131, s39
    v_perm_b32 v151, v134, v133, s39
    ds_write_b128 v53, v[148:151] offset:29120
    s_lshl_b32 s37, s10, 2
    s_add_u32 s37, s37, 16
    s_lshl_b32 s36, s9, 8
    s_add_u32 s36, s36, 69760
    s_mov_b32 m0, s21
    s_cmp_lg_u32 s9, 1
    s_cbranch_scc1 cv_np1
    s_waitcnt vmcnt(0)
    v_cmp_gt_u32 vcc, 16, v52
    s_nop 1
    s_cmp_eq_u64 vcc, 0
    s_cbranch_scc1 cv_np1
    s_mov_b32 s14, 200000
    global_load_dword v52, v55, s[4:5] sc1
pp_l_14:
    s_waitcnt vmcnt(0)
    v_cmp_gt_u32 vcc, 16, v52
    s_nop 1
    s_cmp_eq_u64 vcc, 0
    s_cbranch_scc1 pp_go_13
    s_sleep 1
    global_load_dword v52, v55, s[4:5] sc1
    s_sub_u32 s14, s14, 1
    s_cmp_lg_u32 s14, 0
    s_cbranch_scc1 pp_l_14
pp_go_13:
cv_np1:
    s_barrier
    global_load_lds_dwordx4 v6, s[4:5] offset:0 sc1
    global_load_lds_dwordx4 v6, s[4:5] offset:1024 sc1
    global_load_lds_dwordx4 v6, s[4:5] offset:2048 sc1
    global_load_lds_dwordx4 v6, s[4:5] offset:3072 sc1
    s_mov_b32 m0, s20
    global_load_dword v40, v40, s[4:5] sc1
    global_load_lds_dwordx4 v42, s[4:5] sc1
    s_add_u32 m0, s20, 1024
    v_add_u32 v178, 12288, v177
    global_load_lds_dwordx4 v43, s[4:5] sc1
    global_load_dword v180, v177, s[4:5] sc1
    v_add_u32 v177, 24576, v177
    global_load_dword v181, v178, s[4:5] sc1
    v_add_u32 v178, 24576, v178
    global_load_dword v182, v177, s[4:5] sc1
    global_load_dword v183, v178, s[4:5] sc1
    v_sub_u32 v14, 15, v12
    v_and_b32 v15, 3, v14
    v_sub_u32 v14, v14, v15
    v_lshl_add_u32 v14, v13, 3, v14
    v_lshlrev_b32 v14, 1, v14
    v_mul_u32_u24 v15, 4160, v15
    v_add_u32 v14, v14, v15
    s_mul_i32 s15, s10, 16640
    s_lshl_b32 s18, s11, 8
    s_sub_u32 s15, s15, s18
    s_add_u32 s15, s15, 256
    v_add_u32 v14, s15, v14
    v_lshlrev_b32 v15, 5, v12
    v_lshl_add_u32 v15, v13, 4, v15
    s_mul_i32 s15, s10, 4608
    s_add_u32 s15, s15, 33568
    s_sub_u32 s15, s15, s18
    v_add_u32 v15, s15, v15
    v_lshlrev_b32 v10, 5, v12
    v_lshl_add_u32 v10, v13, 3, v10
    s_mul_i32 s15, s10, 4608
    v_add_u32 v11, s15, v10
    v_lshrrev_b32 v57, 1, v12
    v_lshl_add_u32 v10, v57, 6, v10
    s_lshl_b32 s15, s10, 6
    v_add_u32 v10, s15, v10
    s_and_b32 s15, s12, 3
    s_lshr_b32 s18, s12, 1
    s_and_b32 s18, s18, 4
    s_or_b32 s15, s15, s18
    v_and_b32 v3, 7, v12
    v_xor_b32 v3, s15, v3
    v_lshlrev_b32 v3, 5, v3
    v_lshl_add_u32 v3, v13, 3, v3
    v_lshrrev_b32 v4, 3, v12
    v_mul_u32_u24 v4, 131072, v4
    v_add_u32 v3, v3, v4
    s_lshl_b32 s15, s12, 8
    s_add_u32 s15, s15, 0x300000
    s_mul_i32 s18, s11, 1048576
    s_add_u32 s15, s15, s18
    v_add_u32 v3, s15, v3
    s_lshl_b32 s15, s9, 12
    v_lshl_add_u32 v4, v2, 4, s15
    v_xor_b32 v5, 4096, v4
    v_lshlrev_b32 v252, 4, v2
    s_lshr_b32 s54, s2, 3
    s_lshr_b32 s55, s54, 3
    s_and_b32 s54, s54, 7
    s_mul_i32 s56, s9, 57344
    s_mul_i32 s50, s54, 229376
    s_add_u32 s50, s50, s56
    s_add_u32 s50, s50, 0x900000
    s_add_u32 s50, s4, s50
    s_addc_u32 s51, s5, 0
    s_mov_b64 s[52:53], s[50:51]
    s_add_u32 s54, s54, s55
    s_and_b32 s54, s54, 1
    s_mul_i32 s54, s54, 28672
    s_xor_b32 s55, s54, 28672
    s_and_b32 s31, s2, 15
    s_lshl_b32 s31, s31, 7
    s_add_u32 s31, s31, 0x89000
    v_lshl_add_u32 v240, v12, 11, s31
    v_mov_b32 v241, 1
    s_waitcnt vmcnt(6)
    ds_read_b128 v[24:27], v44
    ds_read_b128 v[28:31], v45
    ds_read_b128 v[32:35], v46
    ds_read_b128 v[36:39], v47
    v_add_f32_dpp v40, v40, v40 quad_perm:[1,0,3,2] row_mask:0xf bank_mask:0xf
    s_nop 1
    v_add_f32_dpp v40, v40, v40 quad_perm:[2,3,0,1] row_mask:0xf bank_mask:0xf
    s_waitcnt vmcnt(4)
    ds_read_b128 v[16:19], v51 offset:42496
    ds_read_b128 v[20:23], v51 offset:42560
    v_cvt_pk_bf16_f32 v40, v40, v40
    v_and_b32 v40, 0xffff0000, v40
    v_add_f32 v41, 1.0, v40
    v_cvt_pk_bf16_f32 v41, v41, v41
    v_and_b32 v41, 0xffff0000, v41
    v_readlane_b32 s41, v40, 0
    v_readlane_b32 s43, v40, 4
    v_readlane_b32 s44, v40, s37
    v_readlane_b32 s40, v41, 8
    v_readlane_b32 s42, v41, 12
    s_waitcnt lgkmcnt(1)
    v_lshlrev_b32 v70, 16, v16
    v_and_b32 v71, 0xffff0000, v16
    v_lshlrev_b32 v72, 16, v17
    v_and_b32 v73, 0xffff0000, v17
    v_lshlrev_b32 v74, 16, v18
    v_and_b32 v75, 0xffff0000, v18
    v_lshlrev_b32 v76, 16, v19
    v_and_b32 v77, 0xffff0000, v19
    v_pk_fma_f32 v[70:71], v[70:71], v[24:25], v[32:33]
    v_pk_fma_f32 v[72:73], v[72:73], v[26:27], v[34:35]
    v_pk_fma_f32 v[74:75], v[74:75], v[28:29], v[36:37]
    v_pk_fma_f32 v[76:77], v[76:77], v[30:31], v[38:39]
    v_pk_fma_f32 v[70:71], v[70:71], s[40:41], s[40:41] op_sel:[0,0,1] op_sel_hi:[1,0,1]
    v_pk_fma_f32 v[72:73], v[72:73], s[40:41], s[40:41] op_sel:[0,0,1] op_sel_hi:[1,0,1]
    v_pk_fma_f32 v[74:75], v[74:75], s[40:41], s[40:41] op_sel:[0,0,1] op_sel_hi:[1,0,1]
    v_pk_fma_f32 v[76:77], v[76:77], s[40:41], s[40:41] op_sel:[0,0,1] op_sel_hi:[1,0,1]
    v_cvt_pk_bf16_f32 v80, v70, v71
    v_cvt_pk_bf16_f32 v81, v72, v73
    v_cvt_pk_bf16_f32 v82, v74, v75
    v_cvt_pk_bf16_f32 v83, v76, v77
    ds_write_b128 v53, v[80:83] offset:33792
    s_waitcnt lgkmcnt(1)
    v_lshlrev_b32 v70, 16, v20
    v_and_b32 v71, 0xffff0000, v20
    v_lshlrev_b32 v72, 16, v21
    v_and_b32 v73, 0xffff0000, v21
    v_lshlrev_b32 v74, 16, v22
    v_and_b32 v75, 0xffff0000, v22
    v_lshlrev_b32 v76, 16, v23
    v_and_b32 v77, 0xffff0000, v23
    v_pk_fma_f32 v[70:71], v[70:71], v[24:25], v[32:33]
    v_pk_fma_f32 v[72:73], v[72:73], v[26:27], v[34:35]
    v_pk_fma_f32 v[74:75], v[74:75], v[28:29], v[36:37]
    v_pk_fma_f32 v[76:77], v[76:77], v[30:31], v[38:39]
    v_pk_fma_f32 v[70:71], v[70:71], s[42:43], s[42:43] op_sel:[0,0,1] op_sel_hi:[1,0,1]
    v_pk_fma_f32 v[72:73], v[72:73], s[42:43], s[42:43] op_sel:[0,0,1] op_sel_hi:[1,0,1]
    v_pk_fma_f32 v[74:75], v[74:75], s[42:43], s[42:43] op_sel:[0,0,1] op_sel_hi:[1,0,1]
    v_pk_fma_f32 v[76:77], v[76:77], s[42:43], s[42:43] op_sel:[0,0,1] op_sel_hi:[1,0,1]
    v_cvt_pk_bf16_f32 v84, v70, v71
    v_cvt_pk_bf16_f32 v85, v72, v73
    v_cvt_pk_bf16_f32 v86, v74, v75
    v_cvt_pk_bf16_f32 v87, v76, v77
    ds_write_b128 v53, v[84:87] offset:38400
    v_mov_b32 v8, s44
    s_waitcnt lgkmcnt(0)
    s_barrier
    ds_read_b64 v[48:49], v14 offset:3776
    ds_read_b64 v[50:51], v14 offset:3784
    ds_read_b128 v[112:115], v15 offset:192
    ds_read_b64 v[52:53], v14 offset:3264
    ds_read_b64 v[54:55], v14 offset:3272
    ds_read_b128 v[116:119], v15 offset:704
    ds_read_b64 v[56:57], v14 offset:2752
    ds_read_b64 v[58:59], v14 offset:2760
    ds_read_b128 v[120:123], v15 offset:1216
    ds_read_b64 v[60:61], v14 offset:2240
    ds_read_b64 v[62:63], v14 offset:2248
    ds_read_b128 v[124:127], v15 offset:1728
    s_waitcnt lgkmcnt(9)
    v_mfma_f32_16x16x32_bf16 v[16:19], v[48:51], v[112:115], 0
    ds_read_b64 v[64:65], v14 offset:1728
    s_waitcnt vmcnt(0)
    v_add_f32 v180, v180, v181
    ds_read_b64 v[66:67], v14 offset:1736
    ds_read_b128 v[128:131], v15 offset:2240
    s_waitcnt lgkmcnt(9)
    v_mfma_f32_16x16x32_bf16 v[20:23], v[52:55], v[112:115], 0
    ds_read_b64 v[68:69], v14 offset:1216
    v_add_f32 v180, v180, v182
    v_mfma_f32_16x16x32_bf16 v[24:27], v[52:55], v[116:119], 0
    ds_read_b64 v[70:71], v14 offset:1224
    v_add_f32 v180, v180, v183
    v_mfma_f32_16x16x32_bf16 v[20:23], v[48:51], v[116:119], v[20:23]
    ds_read_b128 v[132:135], v15 offset:2752
    v_cvt_pk_bf16_f32 v180, v180, v180
    s_waitcnt lgkmcnt(9)
    v_mfma_f32_16x16x32_bf16 v[24:27], v[56:59], v[112:115], v[24:27]
    ds_read_b64 v[72:73], v14 offset:704
    v_and_b32 v180, 0xffff0000, v180
    v_mfma_f32_16x16x32_bf16 v[28:31], v[56:59], v[116:119], 0
    ds_read_b64 v[74:75], v14 offset:712
    v_add_f32 v181, 1.0, v180
    v_mfma_f32_16x16x32_bf16 v[32:35], v[56:59], v[120:123], 0
    ds_read_b128 v[136:139], v15 offset:3264
    v_cvt_pk_bf16_f32 v181, v181, v181
    v_mfma_f32_16x16x32_bf16 v[24:27], v[48:51], v[120:123], v[24:27]
    v_and_b32 v181, 0xffff0000, v181
    v_mfma_f32_16x16x32_bf16 v[28:31], v[52:55], v[120:123], v[28:31]
    v_lshl_add_u32 v182, v2, 2, s36
    s_waitcnt lgkmcnt(9)
    v_mfma_f32_16x16x32_bf16 v[28:31], v[60:63], v[112:115], v[28:31]
    ds_read_b64 v[76:77], v14 offset:192
    v_lshl_add_u32 v183, v2, 1, s36
    v_mfma_f32_16x16x32_bf16 v[32:35], v[60:63], v[116:119], v[32:35]
    ds_read_b64 v[78:79], v14 offset:200
    s_mov_b32 exec_hi, 0
    ds_write_b32 v182, v181
    s_not_b64 exec, exec
    ds_write_b16_d16_hi v183, v180 offset:64
    s_mov_b64 exec, -1
    v_mfma_f32_16x16x32_bf16 v[36:39], v[60:63], v[120:123], 0
    ds_read_b128 v[140:143], v15 offset:3776
    v_lshl_add_u32 v182, v13, 5, s36
    v_mfma_f32_16x16x32_bf16 v[40:43], v[60:63], v[124:127], 0
    v_lshl_add_u32 v183, v13, 4, s36
    v_mfma_f32_16x16x32_bf16 v[28:31], v[48:51], v[124:127], v[28:31]
    ds_read_b128 v[192:195], v182
    v_mfma_f32_16x16x32_bf16 v[32:35], v[52:55], v[124:127], v[32:35]
    ds_read_b128 v[196:199], v182 offset:16
    v_mfma_f32_16x16x32_bf16 v[36:39], v[56:59], v[124:127], v[36:39]
    ds_read_b128 v[200:203], v183 offset:128
    s_waitcnt lgkmcnt(9)
    v_mfma_f32_16x16x32_bf16 v[32:35], v[64:67], v[112:115], v[32:35]
    ds_read_b64 v[80:81], v14 offset:3712
    v_perm_b32 v224, v243, v242, s38
    v_mfma_f32_16x16x32_bf16 v[36:39], v[64:67], v[116:119], v[36:39]
    ds_read_b64 v[82:83], v14 offset:3720
    v_perm_b32 v225, v245, v244, s38
    v_mfma_f32_16x16x32_bf16 v[40:43], v[64:67], v[120:123], v[40:43]
    ds_read_b128 v[144:147], v15 offset:128
    v_perm_b32 v226, v247, v246, s38
    v_mfma_f32_16x16x32_bf16 v[44:47], v[64:67], v[124:127], 0
    v_perm_b32 v227, v249, v248, s38
    v_mfma_f32_16x16x32_bf16 v[32:35], v[48:51], v[128:131], v[32:35]
    s_cmp_ge_u32 s2, 224
    s_cbranch_scc1 cv_sk_15
    global_store_dwordx4 v250, v[224:227], s[4:5] offset:0 sc1
cv_sk_15:
    v_mfma_f32_16x16x32_bf16 v[36:39], v[52:55], v[128:131], v[36:39]
    v_perm_b32 v228, v243, v242, s39
    v_mfma_f32_16x16x32_bf16 v[40:43], v[56:59], v[128:131], v[40:43]
    v_perm_b32 v229, v245, v244, s39
    v_mfma_f32_16x16x32_bf16 v[44:47], v[60:63], v[128:131], v[44:47]
    v_perm_b32 v230, v247, v246, s39
    s_waitcnt lgkmcnt(9)
    v_mfma_f32_16x16x32_bf16 v[36:39], v[68:71], v[112:115], v[36:39]
    ds_read_b64 v[84:85], v14 offset:3200
    v_perm_b32 v231, v249, v248, s39
    v_mfma_f32_16x16x32_bf16 v[40:43], v[68:71], v[116:119], v[40:43]
    ds_read_b64 v[86:87], v14 offset:3208
    s_cmp_ge_u32 s2, 224
    s_cbranch_scc1 cv_sk_16
    global_store_dwordx4 v250, v[228:231], s[4:5] offset:1024 sc1
cv_sk_16:
    v_mfma_f32_16x16x32_bf16 v[44:47], v[68:71], v[120:123], v[44:47]
    ds_read_b128 v[148:151], v15 offset:640
    v_perm_b32 v216, v185, v184, s38
    v_mfma_f32_16x16x32_bf16 v[36:39], v[48:51], v[132:135], v[36:39]
    v_perm_b32 v220, v185, v184, s39
    v_mfma_f32_16x16x32_bf16 v[40:43], v[52:55], v[132:135], v[40:43]
    v_perm_b32 v217, v187, v186, s38
    v_mfma_f32_16x16x32_bf16 v[44:47], v[56:59], v[132:135], v[44:47]
    v_perm_b32 v221, v187, v186, s39
    s_waitcnt lgkmcnt(9)
    v_mfma_f32_16x16x32_bf16 v[40:43], v[72:75], v[112:115], v[40:43]
    ds_read_b64 v[88:89], v14 offset:2688
    v_perm_b32 v218, v189, v188, s38
    v_mfma_f32_16x16x32_bf16 v[44:47], v[72:75], v[116:119], v[44:47]
    ds_read_b64 v[90:91], v14 offset:2696
    v_perm_b32 v222, v189, v188, s39
    v_mfma_f32_16x16x32_bf16 v[40:43], v[48:51], v[136:139], v[40:43]
    ds_read_b128 v[152:155], v15 offset:1152
    v_perm_b32 v219, v191, v190, s38
    v_mfma_f32_16x16x32_bf16 v[44:47], v[52:55], v[136:139], v[44:47]
    v_perm_b32 v223, v191, v190, s39
    s_waitcnt lgkmcnt(9)
    v_mfma_f32_16x16x32_bf16 v[44:47], v[76:79], v[112:115], v[44:47]
    ds_read_b64 v[92:93], v14 offset:2176
    v_mfma_f32_16x16x32_bf16 v[44:47], v[48:51], v[140:143], v[44:47]
    ds_read_b64 v[94:95], v14 offset:2184
    ds_read_b128 v[156:159], v15 offset:1664
    s_waitcnt lgkmcnt(9)
    v_mfma_f32_16x16x32_bf16 v[16:19], v[80:83], v[144:147], v[16:19]
    ds_read_b64 v[96:97], v14 offset:1664
    ds_read_b64 v[98:99], v14 offset:1672
    ds_read_b128 v[160:163], v15 offset:2176
    s_waitcnt lgkmcnt(9)
    v_mfma_f32_16x16x32_bf16 v[20:23], v[84:87], v[144:147], v[20:23]
    ds_read_b64 v[100:101], v14 offset:1152
    v_lshlrev_b32 v204, 16, v184
    v_mfma_f32_16x16x32_bf16 v[24:27], v[84:87], v[148:151], v[24:27]
    ds_read_b64 v[102:103], v14 offset:1160
    v_and_b32 v205, 0xffff0000, v184
    v_mfma_f32_16x16x32_bf16 v[20:23], v[80:83], v[148:151], v[20:23]
    ds_read_b128 v[164:167], v15 offset:2688
    v_mul_f32 v204, v204, v192
    s_waitcnt lgkmcnt(9)
    v_mfma_f32_16x16x32_bf16 v[24:27], v[88:91], v[144:147], v[24:27]
    ds_read_b64 v[104:105], v14 offset:640
    v_mul_f32 v205, v205, v192
    v_mfma_f32_16x16x32_bf16 v[28:31], v[88:91], v[148:151], v[28:31]
    ds_read_b64 v[106:107], v14 offset:648
    v_lshlrev_b32 v206, 16, v185
    v_mfma_f32_16x16x32_bf16 v[32:35], v[88:91], v[152:155], v[32:35]
    ds_read_b128 v[168:171], v15 offset:3200
    v_and_b32 v207, 0xffff0000, v185
    v_mfma_f32_16x16x32_bf16 v[24:27], v[80:83], v[152:155], v[24:27]
    v_mul_f32 v206, v206, v193
    v_mfma_f32_16x16x32_bf16 v[28:31], v[84:87], v[152:155], v[28:31]
    v_mul_f32 v207, v207, v193
    s_waitcnt lgkmcnt(9)
    v_mfma_f32_16x16x32_bf16 v[28:31], v[92:95], v[144:147], v[28:31]
    ds_read_b64 v[108:109], v14 offset:128
    v_cvt_pk_bf16_f32 v208, v204, v206
    v_mfma_f32_16x16x32_bf16 v[32:35], v[92:95], v[148:151], v[32:35]
    ds_read_b64 v[110:111], v14 offset:136
    v_cvt_pk_bf16_f32 v212, v205, v207
    v_mfma_f32_16x16x32_bf16 v[36:39], v[92:95], v[152:155], v[36:39]
    ds_read_b128 v[172:175], v15 offset:3712
    v_lshlrev_b32 v204, 16, v186
    v_mfma_f32_16x16x32_bf16 v[40:43], v[92:95], v[156:159], v[40:43]
    v_and_b32 v205, 0xffff0000, v186
    v_mfma_f32_16x16x32_bf16 v[28:31], v[80:83], v[156:159], v[28:31]
    v_mul_f32 v204, v204, v194
    v_mfma_f32_16x16x32_bf16 v[32:35], v[84:87], v[156:159], v[32:35]
    v_mul_f32 v205, v205, v194
    v_mfma_f32_16x16x32_bf16 v[36:39], v[88:91], v[156:159], v[36:39]
    v_lshlrev_b32 v206, 16, v187
    s_waitcnt lgkmcnt(9)
    v_mfma_f32_16x16x32_bf16 v[32:35], v[96:99], v[144:147], v[32:35]
    ds_read_b64 v[48:49], v14 offset:3648
    v_and_b32 v207, 0xffff0000, v187
    v_mfma_f32_16x16x32_bf16 v[36:39], v[96:99], v[148:151], v[36:39]
    ds_read_b64 v[50:51], v14 offset:3656
    v_mul_f32 v206, v206, v195
    v_mfma_f32_16x16x32_bf16 v[40:43], v[96:99], v[152:155], v[40:43]
    ds_read_b128 v[112:115], v15 offset:64
    v_mul_f32 v207, v207, v195
    v_mfma_f32_16x16x32_bf16 v[44:47], v[96:99], v[156:159], v[44:47]
    v_cvt_pk_bf16_f32 v209, v204, v206
    v_mfma_f32_16x16x32_bf16 v[32:35], v[80:83], v[160:163], v[32:35]
    v_cvt_pk_bf16_f32 v213, v205, v207
    v_mfma_f32_16x16x32_bf16 v[36:39], v[84:87], v[160:163], v[36:39]
    v_lshlrev_b32 v204, 16, v188
    v_mfma_f32_16x16x32_bf16 v[40:43], v[88:91], v[160:163], v[40:43]
    v_and_b32 v205, 0xffff0000, v188
    v_mfma_f32_16x16x32_bf16 v[44:47], v[92:95], v[160:163], v[44:47]
    v_mul_f32 v204, v204, v196
    s_waitcnt lgkmcnt(9)
    v_mfma_f32_16x16x32_bf16 v[36:39], v[100:103], v[144:147], v[36:39]
    ds_read_b64 v[52:53], v14 offset:3136
    v_mul_f32 v205, v205, v196
    v_mfma_f32_16x16x32_bf16 v[40:43], v[100:103], v[148:151], v[40:43]
    ds_read_b64 v[54:55], v14 offset:3144
    v_lshlrev_b32 v206, 16, v189
    v_mfma_f32_16x16x32_bf16 v[44:47], v[100:103], v[152:155], v[44:47]
    ds_read_b128 v[116:119], v15 offset:576
    v_and_b32 v207, 0xffff0000, v189
    v_mfma_f32_16x16x32_bf16 v[36:39], v[80:83], v[164:167], v[36:39]
    v_mul_f32 v206, v206, v197
    v_mfma_f32_16x16x32_bf16 v[40:43], v[84:87], v[164:167], v[40:43]
    v_mul_f32 v207, v207, v197
    v_mfma_f32_16x16x32_bf16 v[44:47], v[88:91], v[164:167], v[44:47]
    v_cvt_pk_bf16_f32 v210, v204, v206
    s_waitcnt lgkmcnt(9)
    v_mfma_f32_16x16x32_bf16 v[40:43], v[104:107], v[144:147], v[40:43]
    ds_read_b64 v[56:57], v14 offset:2624
    v_cvt_pk_bf16_f32 v214, v205, v207
    v_mfma_f32_16x16x32_bf16 v[44:47], v[104:107], v[148:151], v[44:47]
    ds_read_b64 v[58:59], v14 offset:2632
    v_lshlrev_b32 v204, 16, v190
    v_mfma_f32_16x16x32_bf16 v[40:43], v[80:83], v[168:171], v[40:43]
    ds_read_b128 v[120:123], v15 offset:1088
    v_and_b32 v205, 0xffff0000, v190
    v_mfma_f32_16x16x32_bf16 v[44:47], v[84:87], v[168:171], v[44:47]
    v_mul_f32 v204, v204, v198
    s_waitcnt lgkmcnt(9)
    v_mfma_f32_16x16x32_bf16 v[44:47], v[108:111], v[144:147], v[44:47]
    ds_read_b64 v[60:61], v14 offset:2112
    v_mul_f32 v205, v205, v198
    v_mfma_f32_16x16x32_bf16 v[44:47], v[80:83], v[172:175], v[44:47]
    ds_read_b64 v[62:63], v14 offset:2120
    v_lshlrev_b32 v206, 16, v191
    ds_read_b128 v[124:127], v15 offset:1600
    s_waitcnt lgkmcnt(9)
    v_mfma_f32_16x16x32_bf16 v[16:19], v[48:51], v[112:115], v[16:19]
    ds_read_b64 v[64:65], v14 offset:1600
    v_and_b32 v207, 0xffff0000, v191
    ds_read_b64 v[66:67], v14 offset:1608
    ds_read_b128 v[128:131], v15 offset:2112
    s_waitcnt lgkmcnt(9)
    v_mfma_f32_16x16x32_bf16 v[20:23], v[52:55], v[112:115], v[20:23]
    ds_read_b64 v[68:69], v14 offset:1088
    v_mul_f32 v206, v206, v199
    v_mfma_f32_16x16x32_bf16 v[24:27], v[52:55], v[116:119], v[24:27]
    ds_read_b64 v[70:71], v14 offset:1096
    v_mul_f32 v207, v207, v199
    v_mfma_f32_16x16x32_bf16 v[20:23], v[48:51], v[116:119], v[20:23]
    ds_read_b128 v[132:135], v15 offset:2624
    v_cvt_pk_bf16_f32 v211, v204, v206
    s_waitcnt lgkmcnt(9)
    v_mfma_f32_16x16x32_bf16 v[24:27], v[56:59], v[112:115], v[24:27]
    ds_read_b64 v[72:73], v14 offset:576
    v_cvt_pk_bf16_f32 v215, v205, v207
    v_mfma_f32_16x16x32_bf16 v[28:31], v[56:59], v[116:119], v[28:31]
    ds_read_b64 v[74:75], v14 offset:584
    s_lshl_b32 s31, s28, 1
    s_add_u32 s31, s31, 0
    s_mul_i32 s32, s31, 9363
    s_lshr_b32 s32, s32, 16
    s_mul_i32 s32, s32, 105
    s_add_u32 s31, s31, s32
    s_mul_i32 s32, s30, 7
    s_add_u32 s31, s31, s32
    s_lshl_b32 s31, s31, 10
    s_add_u32 s31, s31, 0x700000
    v_lshl_add_u32 v176, v2, 4, s31
    v_mfma_f32_16x16x32_bf16 v[32:35], v[56:59], v[120:123], v[32:35]
    ds_read_b128 v[136:139], v15 offset:3136
    s_cmp_ge_u32 s8, 28
    s_cbranch_scc1 cv_sk_17
    global_store_dwordx4 v176, v[208:211], s[4:5] sc1
cv_sk_17:
    v_mfma_f32_16x16x32_bf16 v[24:27], v[48:51], v[120:123], v[24:27]
    s_lshl_b32 s31, s28, 1
    s_add_u32 s31, s31, 1
    s_mul_i32 s32, s31, 9363
    s_lshr_b32 s32, s32, 16
    s_mul_i32 s32, s32, 105
    s_add_u32 s31, s31, s32
    s_mul_i32 s32, s30, 7
    s_add_u32 s31, s31, s32
    s_lshl_b32 s31, s31, 10
    s_add_u32 s31, s31, 0x700000
    v_lshl_add_u32 v176, v2, 4, s31
    v_mfma_f32_16x16x32_bf16 v[28:31], v[52:55], v[120:123], v[28:31]
    s_cmp_ge_u32 s8, 28
    s_cbranch_scc1 cv_sk_18
    global_store_dwordx4 v176, v[212:215], s[4:5] sc1
cv_sk_18:
    s_waitcnt lgkmcnt(9)
    v_mfma_f32_16x16x32_bf16 v[28:31], v[60:63], v[112:115], v[28:31]
    ds_read_b64 v[76:77], v14 offset:64
    v_mov_b32 v192, 0x3f803f80
    v_mfma_f32_16x16x32_bf16 v[32:35], v[60:63], v[116:119], v[32:35]
    ds_read_b64 v[78:79], v14 offset:72
    v_mov_b32 v193, 0x3f803f80
    v_mfma_f32_16x16x32_bf16 v[36:39], v[60:63], v[120:123], v[36:39]
    ds_read_b128 v[140:143], v15 offset:3648
    v_mov_b32 v194, 0x3f803f80
    v_mfma_f32_16x16x32_bf16 v[40:43], v[60:63], v[124:127], v[40:43]
    v_mov_b32 v195, 0x3f803f80
    v_mfma_f32_16x16x32_bf16 v[28:31], v[48:51], v[124:127], v[28:31]
    s_nop 0
    v_mfma_f32_16x16x32_bf16 v[224:227], v[208:211], v[192:195], 0
    v_mfma_f32_16x16x32_bf16 v[32:35], v[52:55], v[124:127], v[32:35]
    v_mfma_f32_16x16x32_bf16 v[232:235], v[216:219], v[200:203], 0
    v_mfma_f32_16x16x32_bf16 v[36:39], v[56:59], v[124:127], v[36:39]
    v_mfma_f32_16x16x32_bf16 v[228:231], v[212:215], v[192:195], 0
    s_waitcnt lgkmcnt(9)
    v_mfma_f32_16x16x32_bf16 v[32:35], v[64:67], v[112:115], v[32:35]
    ds_read_b64 v[80:81], v14 offset:3584
    v_mfma_f32_16x16x32_bf16 v[236:239], v[220:223], v[200:203], 0
    v_mfma_f32_16x16x32_bf16 v[36:39], v[64:67], v[116:119], v[36:39]
    ds_read_b64 v[82:83], v14 offset:3592
    s_lshl_b32 s31, s9, 8
    s_add_u32 s31, s31, 70784
    v_lshl_add_u32 v182, v13, 4, s31
    v_mfma_f32_16x16x32_bf16 v[40:43], v[64:67], v[120:123], v[40:43]
    ds_read_b128 v[144:147], v15 offset:0
    v_lshlrev_b32 v183, 2, v2
    v_mfma_f32_16x16x32_bf16 v[44:47], v[64:67], v[124:127], v[44:47]
    v_add_u32 v183, 70784, v183
    v_mfma_f32_16x16x32_bf16 v[32:35], v[48:51], v[128:131], v[32:35]
    v_and_b32 v176, 31, v2
    v_mfma_f32_16x16x32_bf16 v[36:39], v[52:55], v[128:131], v[36:39]
    v_lshrrev_b32 v177, 5, v2
    v_mfma_f32_16x16x32_bf16 v[40:43], v[56:59], v[128:131], v[40:43]
    v_mul_u32_u24 v178, 7168, v177
    v_mfma_f32_16x16x32_bf16 v[44:47], v[60:63], v[128:131], v[44:47]
    v_lshl_add_u32 v176, v176, 2, v178
    s_waitcnt lgkmcnt(9)
    v_mfma_f32_16x16x32_bf16 v[36:39], v[68:71], v[112:115], v[36:39]
    ds_read_b64 v[84:85], v14 offset:3072
    s_mul_i32 s31, s29, 14336
    s_lshl_b32 s32, s28, 7
    s_add_u32 s31, s31, s32
    s_add_u32 s31, s31, 0x10000
    v_add_u32 v176, s31, v176
    v_mfma_f32_16x16x32_bf16 v[40:43], v[68:71], v[116:119], v[40:43]
    ds_read_b64 v[86:87], v14 offset:3080
    v_mov_b32 v178, 0x3fb8aa3b
    v_mfma_f32_16x16x32_bf16 v[44:47], v[68:71], v[120:123], v[44:47]
    ds_read_b128 v[148:151], v15 offset:512
    v_cmp_eq_u32 vcc, 0, v177
    v_mfma_f32_16x16x32_bf16 v[36:39], v[48:51], v[132:135], v[36:39]
    s_nop 0
    v_cndmask_b32 v178, v178, 1.0, vcc
    v_mfma_f32_16x16x32_bf16 v[40:43], v[52:55], v[132:135], v[40:43]
    v_mfma_f32_16x16x32_bf16 v[44:47], v[56:59], v[132:135], v[44:47]
    s_waitcnt lgkmcnt(9)
    v_mfma_f32_16x16x32_bf16 v[40:43], v[72:75], v[112:115], v[40:43]
    ds_read_b64 v[88:89], v14 offset:2560
    v_mfma_f32_16x16x32_bf16 v[44:47], v[72:75], v[116:119], v[44:47]
    ds_read_b64 v[90:91], v14 offset:2568
    v_mfma_f32_16x16x32_bf16 v[40:43], v[48:51], v[136:139], v[40:43]
    ds_read_b128 v[152:155], v15 offset:1024
    v_mfma_f32_16x16x32_bf16 v[44:47], v[52:55], v[136:139], v[44:47]
    s_waitcnt lgkmcnt(9)
    v_mfma_f32_16x16x32_bf16 v[44:47], v[76:79], v[112:115], v[44:47]
    ds_read_b64 v[92:93], v14 offset:2048
    v_mfma_f32_16x16x32_bf16 v[44:47], v[48:51], v[140:143], v[44:47]
    ds_read_b64 v[94:95], v14 offset:2056
    ds_read_b128 v[156:159], v15 offset:1536
    s_waitcnt lgkmcnt(9)
    v_mfma_f32_16x16x32_bf16 v[16:19], v[80:83], v[144:147], v[16:19]
    ds_read_b64 v[96:97], v14 offset:1536
    ds_read_b64 v[98:99], v14 offset:1544
    ds_read_b128 v[160:163], v15 offset:2048
    s_waitcnt vmcnt(0)
    s_barrier
    s_cmp_lg_u32 s9, 2
    s_cbranch_scc1 cv_nosig
    s_mov_b64 exec, 0xffff
    global_atomic_add v240, v241, s[4:5] sc1
    s_mov_b64 exec, -1
cv_nosig:
    s_waitcnt lgkmcnt(9)
    v_mfma_f32_16x16x32_bf16 v[20:23], v[84:87], v[144:147], v[20:23]
    ds_read_b64 v[100:101], v14 offset:1024
    v_mfma_f32_16x16x32_bf16 v[24:27], v[84:87], v[148:151], v[24:27]
    ds_read_b64 v[102:103], v14 offset:1032
    v_mfma_f32_16x16x32_bf16 v[20:23], v[80:83], v[148:151], v[20:23]
    ds_read_b128 v[164:167], v15 offset:2560
    s_waitcnt lgkmcnt(9)
    v_mfma_f32_16x16x32_bf16 v[24:27], v[88:91], v[144:147], v[24:27]
    ds_read_b64 v[104:105], v14 offset:512
    v_mfma_f32_16x16x32_bf16 v[28:31], v[88:91], v[148:151], v[28:31]
    ds_read_b64 v[106:107], v14 offset:520
    v_mfma_f32_16x16x32_bf16 v[32:35], v[88:91], v[152:155], v[32:35]
    ds_read_b128 v[168:171], v15 offset:3072
    v_mfma_f32_16x16x32_bf16 v[24:27], v[80:83], v[152:155], v[24:27]
    v_mfma_f32_16x16x32_bf16 v[28:31], v[84:87], v[152:155], v[28:31]
    s_waitcnt lgkmcnt(9)
    v_mfma_f32_16x16x32_bf16 v[28:31], v[92:95], v[144:147], v[28:31]
    ds_read_b64 v[108:109], v14 offset:0
    v_mfma_f32_16x16x32_bf16 v[32:35], v[92:95], v[148:151], v[32:35]
    ds_read_b64 v[110:111], v14 offset:8
    v_mfma_f32_16x16x32_bf16 v[36:39], v[92:95], v[152:155], v[36:39]
    ds_read_b128 v[172:175], v15 offset:3584
    v_mfma_f32_16x16x32_bf16 v[40:43], v[92:95], v[156:159], v[40:43]
    v_mfma_f32_16x16x32_bf16 v[28:31], v[80:83], v[156:159], v[28:31]
    v_mfma_f32_16x16x32_bf16 v[32:35], v[84:87], v[156:159], v[32:35]
    v_mfma_f32_16x16x32_bf16 v[36:39], v[88:91], v[156:159], v[36:39]
    s_waitcnt lgkmcnt(9)
    v_mfma_f32_16x16x32_bf16 v[32:35], v[96:99], v[144:147], v[32:35]
    v_mfma_f32_16x16x32_bf16 v[36:39], v[96:99], v[148:151], v[36:39]
    v_mfma_f32_16x16x32_bf16 v[40:43], v[96:99], v[152:155], v[40:43]
    v_mfma_f32_16x16x32_bf16 v[44:47], v[96:99], v[156:159], v[44:47]
    v_mfma_f32_16x16x32_bf16 v[32:35], v[80:83], v[160:163], v[32:35]
    v_mfma_f32_16x16x32_bf16 v[36:39], v[84:87], v[160:163], v[36:39]
    v_mfma_f32_16x16x32_bf16 v[40:43], v[88:91], v[160:163], v[40:43]
    v_mfma_f32_16x16x32_bf16 v[44:47], v[92:95], v[160:163], v[44:47]
    s_waitcnt lgkmcnt(6)
    v_mfma_f32_16x16x32_bf16 v[36:39], v[100:103], v[144:147], v[36:39]
    v_mfma_f32_16x16x32_bf16 v[40:43], v[100:103], v[148:151], v[40:43]
    v_mfma_f32_16x16x32_bf16 v[44:47], v[100:103], v[152:155], v[44:47]
    v_mfma_f32_16x16x32_bf16 v[36:39], v[80:83], v[164:167], v[36:39]
    v_mfma_f32_16x16x32_bf16 v[40:43], v[84:87], v[164:167], v[40:43]
    v_mfma_f32_16x16x32_bf16 v[44:47], v[88:91], v[164:167], v[44:47]
    s_waitcnt lgkmcnt(3)
    v_mfma_f32_16x16x32_bf16 v[40:43], v[104:107], v[144:147], v[40:43]
    v_mfma_f32_16x16x32_bf16 v[44:47], v[104:107], v[148:151], v[44:47]
    v_mfma_f32_16x16x32_bf16 v[40:43], v[80:83], v[168:171], v[40:43]
    v_mfma_f32_16x16x32_bf16 v[44:47], v[84:87], v[168:171], v[44:47]
    s_waitcnt lgkmcnt(0)
    v_mfma_f32_16x16x32_bf16 v[44:47], v[108:111], v[144:147], v[44:47]
    v_mfma_f32_16x16x32_bf16 v[44:47], v[80:83], v[172:175], v[44:47]
    s_mov_b32 exec_lo, 0x00010001
    s_mov_b32 exec_hi, 0x00010001
    ds_write_b128 v182, v[224:227] offset:0
    ds_write_b128 v182, v[228:231] offset:64
    ds_write_b128 v182, v[232:235] offset:128
    ds_write_b128 v182, v[236:239] offset:192
    s_mov_b64 exec, -1
    s_nop 0
    s_cmp_eq_u32 s11, 1
    s_cbranch_scc1 cv_hf1_19
    ds_write_b128 v4, v[32:35] offset:50688
    ds_write_b128 v4, v[36:39] offset:51712
    ds_write_b128 v4, v[40:43] offset:52736
    ds_write_b128 v4, v[44:47] offset:53760
    ds_read_b64 v[64:65], v11 offset:33792
    ds_read_b64 v[72:73], v10 offset:42496
    ds_read_b64 v[66:67], v11 offset:34304
    ds_read_b64 v[74:75], v10 offset:43520
    ds_read_b64 v[68:69], v11 offset:34816
    ds_read_b64 v[76:77], v10 offset:44544
    ds_read_b64 v[70:71], v11 offset:35328
    ds_read_b64 v[78:79], v10 offset:45568
    s_waitcnt lgkmcnt(0)
    s_barrier
    ds_read_b128 v[48:51], v5 offset:50688
    ds_read_b128 v[52:55], v5 offset:51712
    ds_read_b128 v[56:59], v5 offset:52736
    ds_read_b128 v[60:63], v5 offset:53760
    v_lshlrev_b32 v80, 16, v64
    v_and_b32 v81, 0xffff0000, v64
    v_lshlrev_b32 v82, 16, v65
    v_and_b32 v83, 0xffff0000, v65
    v_pk_fma_f32 v[16:17], v[80:81], v[8:9], v[16:17] op_sel:[0,1,0] op_sel_hi:[1,1,1]
    v_pk_fma_f32 v[18:19], v[82:83], v[8:9], v[18:19] op_sel:[0,1,0] op_sel_hi:[1,1,1]
    v_lshlrev_b32 v84, 16, v72
    v_and_b32 v85, 0xffff0000, v72
    v_lshlrev_b32 v86, 16, v73
    v_and_b32 v87, 0xffff0000, v73
    v_lshlrev_b32 v80, 16, v66
    v_and_b32 v81, 0xffff0000, v66
    v_lshlrev_b32 v82, 16, v67
    v_and_b32 v83, 0xffff0000, v67
    v_pk_fma_f32 v[20:21], v[80:81], v[8:9], v[20:21] op_sel:[0,1,0] op_sel_hi:[1,1,1]
    v_pk_fma_f32 v[22:23], v[82:83], v[8:9], v[22:23] op_sel:[0,1,0] op_sel_hi:[1,1,1]
    v_lshlrev_b32 v88, 16, v74
    v_and_b32 v89, 0xffff0000, v74
    v_lshlrev_b32 v90, 16, v75
    v_and_b32 v91, 0xffff0000, v75
    v_lshlrev_b32 v80, 16, v68
    v_and_b32 v81, 0xffff0000, v68
    v_lshlrev_b32 v82, 16, v69
    v_and_b32 v83, 0xffff0000, v69
    v_pk_fma_f32 v[24:25], v[80:81], v[8:9], v[24:25] op_sel:[0,1,0] op_sel_hi:[1,1,1]
    v_pk_fma_f32 v[26:27], v[82:83], v[8:9], v[26:27] op_sel:[0,1,0] op_sel_hi:[1,1,1]
    v_lshlrev_b32 v92, 16, v76
    v_and_b32 v93, 0xffff0000, v76
    v_lshlrev_b32 v94, 16, v77
    v_and_b32 v95, 0xffff0000, v77
    v_lshlrev_b32 v80, 16, v70
    v_and_b32 v81, 0xffff0000, v70
    v_lshlrev_b32 v82, 16, v71
    v_and_b32 v83, 0xffff0000, v71
    v_pk_fma_f32 v[28:29], v[80:81], v[8:9], v[28:29] op_sel:[0,1,0] op_sel_hi:[1,1,1]
    v_pk_fma_f32 v[30:31], v[82:83], v[8:9], v[30:31] op_sel:[0,1,0] op_sel_hi:[1,1,1]
    v_lshlrev_b32 v96, 16, v78
    v_and_b32 v97, 0xffff0000, v78
    v_lshlrev_b32 v98, 16, v79
    v_and_b32 v99, 0xffff0000, v79
    s_waitcnt lgkmcnt(3)
    v_pk_add_f32 v[16:17], v[16:17], v[48:49]
    v_pk_add_f32 v[18:19], v[18:19], v[50:51]
    v_pk_fma_f32 v[16:17], v[16:17], v[8:9], v[84:85] op_sel:[0,0,0] op_sel_hi:[1,0,1]
    v_pk_fma_f32 v[18:19], v[18:19], v[8:9], v[86:87] op_sel:[0,0,0] op_sel_hi:[1,0,1]
    v_cvt_pk_bf16_f32 v100, v16, v17
    v_cvt_pk_bf16_f32 v101, v18, v19
    global_store_dwordx2 v3, v[100:101], s[4:5] sc1
    s_waitcnt lgkmcnt(2)
    v_pk_add_f32 v[20:21], v[20:21], v[52:53]
    v_pk_add_f32 v[22:23], v[22:23], v[54:55]
    v_pk_fma_f32 v[20:21], v[20:21], v[8:9], v[88:89] op_sel:[0,0,0] op_sel_hi:[1,0,1]
    v_pk_fma_f32 v[22:23], v[22:23], v[8:9], v[90:91] op_sel:[0,0,0] op_sel_hi:[1,0,1]
    v_cvt_pk_bf16_f32 v102, v20, v21
    v_cvt_pk_bf16_f32 v103, v22, v23
    v_add_u32 v3, 262144, v3
    global_store_dwordx2 v3, v[102:103], s[4:5] sc1
    s_waitcnt lgkmcnt(1)
    v_pk_add_f32 v[24:25], v[24:25], v[56:57]
    v_pk_add_f32 v[26:27], v[26:27], v[58:59]
    v_pk_fma_f32 v[24:25], v[24:25], v[8:9], v[92:93] op_sel:[0,0,0] op_sel_hi:[1,0,1]
    v_pk_fma_f32 v[26:27], v[26:27], v[8:9], v[94:95] op_sel:[0,0,0] op_sel_hi:[1,0,1]
    v_cvt_pk_bf16_f32 v104, v24, v25
    v_cvt_pk_bf16_f32 v105, v26, v27
    v_add_u32 v3, 262144, v3
    global_store_dwordx2 v3, v[104:105], s[4:5] sc1
    s_waitcnt lgkmcnt(0)
    v_pk_add_f32 v[28:29], v[28:29], v[60:61]
    v_pk_add_f32 v[30:31], v[30:31], v[62:63]
    v_pk_fma_f32 v[28:29], v[28:29], v[8:9], v[96:97] op_sel:[0,0,0] op_sel_hi:[1,0,1]
    v_pk_fma_f32 v[30:31], v[30:31], v[8:9], v[98:99] op_sel:[0,0,0] op_sel_hi:[1,0,1]
    v_cvt_pk_bf16_f32 v106, v28, v29
    v_cvt_pk_bf16_f32 v107, v30, v31
    v_add_u32 v3, 262144, v3
    global_store_dwordx2 v3, v[106:107], s[4:5] sc1
    s_cmp_lg_u32 s9, 0
    s_cbranch_scc1 cv_nouv_20
    s_cmp_ge_u32 s8, 28
    s_cbranch_scc1 cv_nouv_20
    ds_read_b32 v184, v183 offset:0
    ds_read_b32 v185, v183 offset:256
    ds_read_b32 v186, v183 offset:512
    ds_read_b32 v187, v183 offset:768
    s_waitcnt lgkmcnt(0)
    v_add_f32 v184, v184, v185
    v_add_f32 v186, v186, v187
    v_add_f32 v184, v184, v186
    v_mul_f32 v184, v184, v178
    global_store_dword v176, v184, s[4:5] sc1
cv_nouv_20:
    s_nop 0
    s_branch k23_sync
cv_hf1_19:
    ds_write_b128 v4, v[16:19] offset:50688
    ds_write_b128 v4, v[20:23] offset:51712
    ds_write_b128 v4, v[24:27] offset:52736
    ds_write_b128 v4, v[28:31] offset:53760
    ds_read_b64 v[64:65], v11 offset:35840
    ds_read_b64 v[72:73], v10 offset:46592
    ds_read_b64 v[66:67], v11 offset:36352
    ds_read_b64 v[74:75], v10 offset:47616
    ds_read_b64 v[68:69], v11 offset:36864
    ds_read_b64 v[76:77], v10 offset:48640
    ds_read_b64 v[70:71], v11 offset:37376
    ds_read_b64 v[78:79], v10 offset:49664
    s_waitcnt lgkmcnt(0)
    s_barrier
    ds_read_b128 v[48:51], v5 offset:50688
    ds_read_b128 v[52:55], v5 offset:51712
    ds_read_b128 v[56:59], v5 offset:52736
    ds_read_b128 v[60:63], v5 offset:53760
    v_lshlrev_b32 v80, 16, v64
    v_and_b32 v81, 0xffff0000, v64
    v_lshlrev_b32 v82, 16, v65
    v_and_b32 v83, 0xffff0000, v65
    v_pk_fma_f32 v[32:33], v[80:81], v[8:9], v[32:33] op_sel:[0,1,0] op_sel_hi:[1,1,1]
    v_pk_fma_f32 v[34:35], v[82:83], v[8:9], v[34:35] op_sel:[0,1,0] op_sel_hi:[1,1,1]
    v_lshlrev_b32 v84, 16, v72
    v_and_b32 v85, 0xffff0000, v72
    v_lshlrev_b32 v86, 16, v73
    v_and_b32 v87, 0xffff0000, v73
    v_lshlrev_b32 v80, 16, v66
    v_and_b32 v81, 0xffff0000, v66
    v_lshlrev_b32 v82, 16, v67
    v_and_b32 v83, 0xffff0000, v67
    v_pk_fma_f32 v[36:37], v[80:81], v[8:9], v[36:37] op_sel:[0,1,0] op_sel_hi:[1,1,1]
    v_pk_fma_f32 v[38:39], v[82:83], v[8:9], v[38:39] op_sel:[0,1,0] op_sel_hi:[1,1,1]
    v_lshlrev_b32 v88, 16, v74
    v_and_b32 v89, 0xffff0000, v74
    v_lshlrev_b32 v90, 16, v75
    v_and_b32 v91, 0xffff0000, v75
    v_lshlrev_b32 v80, 16, v68
    v_and_b32 v81, 0xffff0000, v68
    v_lshlrev_b32 v82, 16, v69
    v_and_b32 v83, 0xffff0000, v69
    v_pk_fma_f32 v[40:41], v[80:81], v[8:9], v[40:41] op_sel:[0,1,0] op_sel_hi:[1,1,1]
    v_pk_fma_f32 v[42:43], v[82:83], v[8:9], v[42:43] op_sel:[0,1,0] op_sel_hi:[1,1,1]
    v_lshlrev_b32 v92, 16, v76
    v_and_b32 v93, 0xffff0000, v76
    v_lshlrev_b32 v94, 16, v77
    v_and_b32 v95, 0xffff0000, v77
    v_lshlrev_b32 v80, 16, v70
    v_and_b32 v81, 0xffff0000, v70
    v_lshlrev_b32 v82, 16, v71
    v_and_b32 v83, 0xffff0000, v71
    v_pk_fma_f32 v[44:45], v[80:81], v[8:9], v[44:45] op_sel:[0,1,0] op_sel_hi:[1,1,1]
    v_pk_fma_f32 v[46:47], v[82:83], v[8:9], v[46:47] op_sel:[0,1,0] op_sel_hi:[1,1,1]
    v_lshlrev_b32 v96, 16, v78
    v_and_b32 v97, 0xffff0000, v78
    v_lshlrev_b32 v98, 16, v79
    v_and_b32 v99, 0xffff0000, v79
    s_waitcnt lgkmcnt(3)
    v_pk_add_f32 v[32:33], v[32:33], v[48:49]
    v_pk_add_f32 v[34:35], v[34:35], v[50:51]
    v_pk_fma_f32 v[32:33], v[32:33], v[8:9], v[84:85] op_sel:[0,0,0] op_sel_hi:[1,0,1]
    v_pk_fma_f32 v[34:35], v[34:35], v[8:9], v[86:87] op_sel:[0,0,0] op_sel_hi:[1,0,1]
    v_cvt_pk_bf16_f32 v100, v32, v33
    v_cvt_pk_bf16_f32 v101, v34, v35
    global_store_dwordx2 v3, v[100:101], s[4:5] sc1
    s_waitcnt lgkmcnt(2)
    v_pk_add_f32 v[36:37], v[36:37], v[52:53]
    v_pk_add_f32 v[38:39], v[38:39], v[54:55]
    v_pk_fma_f32 v[36:37], v[36:37], v[8:9], v[88:89] op_sel:[0,0,0] op_sel_hi:[1,0,1]
    v_pk_fma_f32 v[38:39], v[38:39], v[8:9], v[90:91] op_sel:[0,0,0] op_sel_hi:[1,0,1]
    v_cvt_pk_bf16_f32 v102, v36, v37
    v_cvt_pk_bf16_f32 v103, v38, v39
    v_add_u32 v3, 262144, v3
    global_store_dwordx2 v3, v[102:103], s[4:5] sc1
    s_waitcnt lgkmcnt(1)
    v_pk_add_f32 v[40:41], v[40:41], v[56:57]
    v_pk_add_f32 v[42:43], v[42:43], v[58:59]
    v_pk_fma_f32 v[40:41], v[40:41], v[8:9], v[92:93] op_sel:[0,0,0] op_sel_hi:[1,0,1]
    v_pk_fma_f32 v[42:43], v[42:43], v[8:9], v[94:95] op_sel:[0,0,0] op_sel_hi:[1,0,1]
    v_cvt_pk_bf16_f32 v104, v40, v41
    v_cvt_pk_bf16_f32 v105, v42, v43
    v_add_u32 v3, 262144, v3
    global_store_dwordx2 v3, v[104:105], s[4:5] sc1
    s_waitcnt lgkmcnt(0)
    v_pk_add_f32 v[44:45], v[44:45], v[60:61]
    v_pk_add_f32 v[46:47], v[46:47], v[62:63]
    v_pk_fma_f32 v[44:45], v[44:45], v[8:9], v[96:97] op_sel:[0,0,0] op_sel_hi:[1,0,1]
    v_pk_fma_f32 v[46:47], v[46:47], v[8:9], v[98:99] op_sel:[0,0,0] op_sel_hi:[1,0,1]
    v_cvt_pk_bf16_f32 v106, v44, v45
    v_cvt_pk_bf16_f32 v107, v46, v47
    v_add_u32 v3, 262144, v3
    global_store_dwordx2 v3, v[106:107], s[4:5] sc1
    s_nop 0
k23_sync:
    v_and_b32 v167, 15, v0
    s_and_b32 s14, s2, 15
    s_lshl_b32 s14, s14, 7
    s_add_u32 s14, s14, 0x81000
    v_lshl_add_u32 v164, v167, 11, s14
    s_lshr_b32 s14, s2, 4
    s_lshl_b32 s14, s14, 11
    s_add_u32 s14, s14, 0x81000
    v_lshl_add_u32 v165, v167, 7, s14
    v_add_u32 v166, 32768, v165
    s_cmp_lg_u32 s9, 2
    s_cbranch_scc1 s2a_np
    global_load_dword v171, v166, s[4:5] sc1
s2a_np:
    s_and_b32 s3, s2, 7
    s_lshr_b32 s17, s2, 3
    s_lshr_b32 s16, s17, 3
    s_and_b32 s17, s17, 7
    s_lshr_b32 s9, s3, 1
    s_lshl_b32 s9, s9, 2
    s_add_u32 s9, s9, s16
    s_and_b32 s3, s3, 1
    s_lshl_b32 s8, s3, 3
    s_add_u32 s8, s8, s17
    v_lshrrev_b32 v1, 6, v0
    v_and_b32 v2, 63, v0
    v_readfirstlane_b32 s10, v1
    v_and_b32 v3, 15, v0
    v_bfe_u32 v4, v0, 4, 2
    s_mul_i32 s20, s9, 131072
    s_add_u32 s20, s20, 0x300000
    s_mul_i32 s21, s8, 114688
    s_add_u32 s21, s21, 0x700000
    s_lshl_b32 s12, s10, 12
    s_add_u32 s11, s20, s12
    s_add_u32 s13, s21, s12
    s_mov_b32 s44, s17
    v_lshlrev_b32 v5, 4, v2
    s_lshl_b32 s14, s8, 13
    s_add_u32 s14, s14, s20
    s_lshl_b32 s36, s10, 11
    s_add_u32 s14, s14, s36
    v_add_u32 v11, s14, v5
    s_add_u32 s36, s36, 124160
    v_bfe_u32 v18, v0, 2, 2
    v_and_b32 v19, 3, v0
    v_and_b32 v17, 1, v4
    v_lshl_or_b32 v17, v17, 2, v18
    v_lshl_add_u32 v15, v4, 3, v18
    v_lshlrev_b32 v15, 8, v15
    v_lshl_add_u32 v15, v19, 3, v15
    s_lshl_b32 s14, s10, 1
    v_xor_b32 v17, s14, v17
    v_lshl_add_u32 v12, v17, 5, v15
    v_xor_b32 v13, 32, v12
    v_add_u32 v14, 16384, v5
    v_add_u32 v168, 61440, v12
    v_add_u32 v169, 61440, v13
    v_add_u32 v170, 61440, v14
    v_and_b32 v17, 1, v4
    v_lshl_or_b32 v17, v17, 2, v18
    s_lshl_b32 s14, s3, 2
    s_add_u32 s14, s14, s10
    v_xor_b32 v17, s14, v17
    v_lshl_add_u32 v15, v17, 5, v15
    s_and_b32 s14, s17, 3
    s_mul_i32 s14, s14, 30720
    v_add_u32 v15, s14, v15
    s_add_u32 s18, s4, s11
    s_addc_u32 s19, s5, 0
    s_add_u32 s46, s4, s13
    s_addc_u32 s47, s5, 0
    v_mov_b32 v190, v11
    v_cmp_lt_u32 vcc, 111, v0
    v_mov_b32 v7, 6720
    s_nop 0
    v_cndmask_b32 v7, 0, v7, vcc
    v_min_u32 v8, 223, v0
    v_lshl_add_u32 v7, v8, 2, v7
    s_mul_i32 s14, s8, 448
    s_add_u32 s14, s14, 0x10000
    v_add_u32 v7, s14, v7
    v_lshlrev_b32 v8, 2, v8
    v_add_u32 v8, 122880, v8
    s_lshl_b32 s14, s17, 8
    s_add_u32 s14, s14, 206848
    v_lshl_add_u32 v192, v2, 2, s14
    v_mov_b32 v16, 0x3f803f80
    v_mov_b32 v17, 0x3f803f80
    v_mov_b32 v18, 0x3f803f80
    v_mov_b32 v19, 0x3f803f80
    s_lshl_b32 s14, s9, 1
    s_lshr_b32 s15, s10, 1
    s_add_u32 s14, s14, s15
    s_mul_i32 s14, s14, 56
    s_lshr_b32 s15, s8, 1
    s_mul_i32 s15, s15, 7
    s_add_u32 s14, s14, s15
    s_lshl_b32 s14, s14, 12
    s_and_b32 s15, s10, 1
    s_lshl_b32 s15, s15, 11
    s_add_u32 s14, s14, s15
    s_add_u32 s14, s14, 0x1000000
    s_and_b32 s15, s8, 1
    s_mul_i32 s23, s15, 12288
    s_add_u32 s23, s23, s14
    v_lshl_add_u32 v9, v2, 4, s23
    s_lshl_b32 s15, s15, 9
    s_add_u32 s14, s14, s15
    s_add_u32 s14, s14, 24576
    v_lshl_add_u32 v10, v2, 3, s14
    s_mov_b32 s34, 0x3fb8aa3b
    s_mov_b32 s35, 0x3fb8aa3b
    s_lshl_b32 s14, s9, 8
    s_add_u32 s14, s14, 0x80000
    v_mov_b32 v253, s14
    v_mov_b32 v254, 1
    s_lshl_b32 s14, s9, 14
    s_lshl_b32 s15, s10, 8
    s_add_u32 s14, s14, s15
    s_add_u32 s14, s14, 0x40000
    v_lshl_add_u32 v11, v3, 3, s14
    v_lshl_add_u32 v191, v4, 12, v11
    s_lshl_b32 s15, s8, 10
    v_add_u32 v11, s15, v11
    v_and_b32 v1, 3, v0
    s_waitcnt vmcnt(0)
    s_cmp_lg_u32 s10, 2
    s_cbranch_scc1 s2a_ok
    v_cmp_gt_u32 vcc, 16, v171
    s_nop 1
    s_cmp_eq_u64 vcc, 0
    s_cbranch_scc1 s2a_ok
    s_cmp_lg_u32 s10, 2
    s_cbranch_scc1 s2_go_21
    s_mov_b32 s14, 200000
s2_poll_22:
    global_load_dword v171, v166, s[4:5] sc1
    s_waitcnt vmcnt(0)
    v_cmp_gt_u32 vcc, 16, v171
    s_nop 1
    s_cmp_eq_u64 vcc, 0
    s_cbranch_scc1 s2_go_21
    s_sleep 1
    s_sub_u32 s14, s14, 1
    s_cmp_lg_u32 s14, 0
    s_cbranch_scc1 s2_poll_22
s2_go_21:
s2a_ok:
    s_barrier
    s_cmp_lg_u32 s10, 0
    s_cbranch_scc1 s2_sig_24
    s_mov_b64 exec, 0xffff
    global_atomic_add v164, v254, s[4:5] sc1
    s_mov_b64 exec, -1
s2_sig_24:
    s_add_u32 m0, s12, 16384
    s_nop 0
    global_load_lds_dwordx4 v5, s[46:47] offset:0 sc1
    s_add_u32 m0, s12, 16384
    s_nop 0
    global_load_lds_dwordx4 v5, s[46:47] offset:1024 sc1
    s_add_u32 m0, s12, 16384
    s_cmp_lt_u32 s10, 3
    s_cbranch_scc0 g1_skip_25
    global_load_lds_dwordx4 v5, s[46:47] offset:2048 sc1
    global_load_lds_dwordx4 v5, s[46:47] offset:3072 sc1
g1_skip_25:
    s_add_u32 s46, s46, 14336
    s_addc_u32 s47, s47, 0
    s_add_u32 m0, s12, 47104
    s_nop 0
    global_load_lds_dwordx4 v5, s[46:47] offset:0 sc1
    s_add_u32 m0, s12, 47104
    s_nop 0
    global_load_lds_dwordx4 v5, s[46:47] offset:1024 sc1
    s_add_u32 m0, s12, 47104
    s_cmp_lt_u32 s10, 3
    s_cbranch_scc0 g1_skip_26
    global_load_lds_dwordx4 v5, s[46:47] offset:2048 sc1
    global_load_lds_dwordx4 v5, s[46:47] offset:3072 sc1
g1_skip_26:
    s_add_u32 s46, s46, 14336
    s_addc_u32 s47, s47, 0
    s_add_u32 m0, s12, 77824
    s_nop 0
    global_load_lds_dwordx4 v5, s[46:47] offset:0 sc1
    s_add_u32 m0, s12, 77824
    s_nop 0
    global_load_lds_dwordx4 v5, s[46:47] offset:1024 sc1
    s_add_u32 m0, s12, 77824
    s_cmp_lt_u32 s10, 3
    s_cbranch_scc0 g1_skip_27
    global_load_lds_dwordx4 v5, s[46:47] offset:2048 sc1
    global_load_lds_dwordx4 v5, s[46:47] offset:3072 sc1
g1_skip_27:
    s_add_u32 s46, s46, 14336
    s_addc_u32 s47, s47, 0
    s_add_u32 m0, s12, 108544
    s_nop 0
    global_load_lds_dwordx4 v5, s[46:47] offset:0 sc1
    s_add_u32 m0, s12, 108544
    s_nop 0
    global_load_lds_dwordx4 v5, s[46:47] offset:1024 sc1
    s_add_u32 m0, s12, 108544
    s_cmp_lt_u32 s10, 3
    s_cbranch_scc0 g1_skip_28
    global_load_lds_dwordx4 v5, s[46:47] offset:2048 sc1
    global_load_lds_dwordx4 v5, s[46:47] offset:3072 sc1
g1_skip_28:
    s_add_u32 s52, s50, s54
    s_addc_u32 s53, s51, 0
    global_load_dwordx4 a[0:3], v252, s[52:53] offset:0 sc1
    global_load_dwordx4 a[4:7], v252, s[52:53] offset:1024 sc1
    global_load_dwordx4 a[8:11], v252, s[52:53] offset:2048 sc1
    global_load_dwordx4 a[12:15], v252, s[52:53] offset:3072 sc1
    s_add_u32 s52, s52, 4096
    s_addc_u32 s53, s53, 0
    global_load_dwordx4 a[16:19], v252, s[52:53] offset:0 sc1
    global_load_dwordx4 a[20:23], v252, s[52:53] offset:1024 sc1
    global_load_dwordx4 a[24:27], v252, s[52:53] offset:2048 sc1
    global_load_dwordx4 a[28:31], v252, s[52:53] offset:3072 sc1
    s_add_u32 s52, s52, 4096
    s_addc_u32 s53, s53, 0
    global_load_dwordx4 a[32:35], v252, s[52:53] offset:0 sc1
    global_load_dwordx4 a[36:39], v252, s[52:53] offset:1024 sc1
    s_cmp_lg_u32 s10, 3
    s_cbranch_scc1 s2_np
    s_mov_b32 s14, 200000
    global_load_dword v171, v165, s[4:5] sc1
pp_l_30:
    s_waitcnt vmcnt(0)
    v_cmp_gt_u32 vcc, 16, v171
    s_nop 1
    s_cmp_eq_u64 vcc, 0
    s_cbranch_scc1 pp_go_29
    s_sleep 1
    global_load_dword v171, v165, s[4:5] sc1
    s_sub_u32 s14, s14, 1
    s_cmp_lg_u32 s14, 0
    s_cbranch_scc1 pp_l_30
pp_go_29:
s2_np:
    s_barrier
    s_add_u32 m0, s12, 0
    s_nop 0
    global_load_lds_dwordx4 v5, s[18:19] offset:0 sc1
    s_add_u32 m0, s12, 0
    s_nop 0
    global_load_lds_dwordx4 v5, s[18:19] offset:1024 sc1
    s_add_u32 m0, s12, 0
    s_nop 0
    global_load_lds_dwordx4 v5, s[18:19] offset:2048 sc1
    s_add_u32 m0, s12, 0
    s_nop 0
    global_load_lds_dwordx4 v5, s[18:19] offset:3072 sc1
    s_mov_b32 m0, s36
    s_nop 0
    global_load_lds_dwordx4 v190, s[4:5] sc1
    global_load_lds_dwordx4 v190, s[4:5] offset:1024 sc1
    s_add_u32 s18, s18, 16384
    s_addc_u32 s19, s19, 0
    s_add_u32 m0, s12, 30720
    s_nop 0
    global_load_lds_dwordx4 v5, s[18:19] offset:0 sc1
    s_add_u32 m0, s12, 30720
    s_nop 0
    global_load_lds_dwordx4 v5, s[18:19] offset:1024 sc1
    s_add_u32 m0, s12, 30720
    s_nop 0
    global_load_lds_dwordx4 v5, s[18:19] offset:2048 sc1
    s_add_u32 m0, s12, 30720
    s_nop 0
    global_load_lds_dwordx4 v5, s[18:19] offset:3072 sc1
    s_add_u32 s18, s18, 16384
    s_addc_u32 s19, s19, 0
    s_add_u32 m0, s12, 61440
    s_nop 0
    global_load_lds_dwordx4 v5, s[18:19] offset:0 sc1
    s_add_u32 m0, s12, 61440
    s_nop 0
    global_load_lds_dwordx4 v5, s[18:19] offset:1024 sc1
    s_add_u32 m0, s12, 61440
    s_nop 0
    global_load_lds_dwordx4 v5, s[18:19] offset:2048 sc1
    s_add_u32 m0, s12, 61440
    s_nop 0
    global_load_lds_dwordx4 v5, s[18:19] offset:3072 sc1
    s_waitcnt vmcnt(10)
    s_barrier
    s_cmp_eq_u32 s44, 0
    s_cbranch_scc0 g1_nx_31
    ds_read_b64_tr_b16 v[228:229], v15 offset:0
    ds_read_b64_tr_b16 v[230:231], v15 offset:1024
    ds_read_b64_tr_b16 v[232:233], v15 offset:8192
    ds_read_b64_tr_b16 v[234:235], v15 offset:9216
g1_nx_31:
    ds_read_b64_tr_b16 v[92:93], v12 offset:0
    ds_read_b64_tr_b16 v[94:95], v12 offset:1024
    ds_read_b64_tr_b16 v[96:97], v13 offset:0
    ds_read_b64_tr_b16 v[98:99], v13 offset:1024
    ds_read_b128 v[100:103], v14 offset:0
    ds_read_b128 v[104:107], v14 offset:1024
    ds_read_b128 v[108:111], v14 offset:2048
    ds_read_b128 v[112:115], v14 offset:3072
    ds_read_b128 v[116:119], v14 offset:4096
    ds_read_b128 v[120:123], v14 offset:5120
    ds_read_b128 v[124:127], v14 offset:6144
    s_waitcnt lgkmcnt(0)
    v_mfma_f32_16x16x32_bf16 v[20:23], v[100:103], v[92:95], 0
    ds_read_b64_tr_b16 v[128:129], v12 offset:8192
    v_mfma_f32_16x16x32_bf16 v[48:51], v[100:103], v[96:99], 0
    ds_read_b64_tr_b16 v[130:131], v12 offset:9216
    s_add_u32 s18, s18, 16384
    s_addc_u32 s19, s19, 0
    s_add_u32 m0, s12, 92160
    s_nop 0
    global_load_lds_dwordx4 v5, s[18:19] offset:0 sc1
    v_mfma_f32_16x16x32_bf16 v[24:27], v[104:107], v[92:95], 0
    ds_read_b64_tr_b16 v[132:133], v13 offset:8192
    v_mfma_f32_16x16x32_bf16 v[52:55], v[104:107], v[96:99], 0
    ds_read_b64_tr_b16 v[134:135], v13 offset:9216
    v_mfma_f32_16x16x32_bf16 v[28:31], v[108:111], v[92:95], 0
    ds_read_b128 v[136:139], v14 offset:7168
    v_mfma_f32_16x16x32_bf16 v[56:59], v[108:111], v[96:99], 0
    ds_read_b128 v[140:143], v14 offset:8192
    s_add_u32 m0, s12, 92160
    s_nop 0
    global_load_lds_dwordx4 v5, s[18:19] offset:1024 sc1
    v_mfma_f32_16x16x32_bf16 v[32:35], v[112:115], v[92:95], 0
    ds_read_b128 v[144:147], v14 offset:9216
    v_mfma_f32_16x16x32_bf16 v[60:63], v[112:115], v[96:99], 0
    ds_read_b128 v[148:151], v14 offset:10240
    v_mfma_f32_16x16x32_bf16 v[36:39], v[116:119], v[92:95], 0
    ds_read_b128 v[152:155], v14 offset:11264
    s_add_u32 m0, s12, 92160
    s_nop 0
    global_load_lds_dwordx4 v5, s[18:19] offset:2048 sc1
    v_mfma_f32_16x16x32_bf16 v[64:67], v[116:119], v[96:99], 0
    ds_read_b128 v[156:159], v14 offset:12288
    v_mfma_f32_16x16x32_bf16 v[40:43], v[120:123], v[92:95], 0
    ds_read_b128 v[160:163], v14 offset:13312
    v_mfma_f32_16x16x32_bf16 v[68:71], v[120:123], v[96:99], 0
    v_mfma_f32_16x16x32_bf16 v[44:47], v[124:127], v[92:95], 0
    s_add_u32 m0, s12, 92160
    s_nop 0
    global_load_lds_dwordx4 v5, s[18:19] offset:3072 sc1
    v_mfma_f32_16x16x32_bf16 v[72:75], v[124:127], v[96:99], 0
    s_waitcnt vmcnt(8) lgkmcnt(0)
    s_barrier
    s_cmp_eq_u32 s44, 1
    s_cbranch_scc0 g1_nx_32
    ds_read_b64_tr_b16 v[228:229], v15 offset:0
    ds_read_b64_tr_b16 v[230:231], v15 offset:1024
    ds_read_b64_tr_b16 v[232:233], v15 offset:8192
    ds_read_b64_tr_b16 v[234:235], v15 offset:9216
g1_nx_32:
    v_mfma_f32_16x16x32_bf16 v[20:23], v[136:139], v[128:131], v[20:23]
    ds_read_b64_tr_b16 v[92:93], v12 offset:30720
    ds_read_b64_tr_b16 v[94:95], v12 offset:31744
    v_mfma_f32_16x16x32_bf16 v[48:51], v[136:139], v[132:135], v[48:51]
    ds_read_b64_tr_b16 v[96:97], v13 offset:30720
    ds_read_b64_tr_b16 v[98:99], v13 offset:31744
    s_add_u32 s18, s18, 16384
    s_addc_u32 s19, s19, 0
    s_add_u32 m0, s12, 0
    s_nop 0
    global_load_lds_dwordx4 v5, s[18:19] offset:0 sc1
    v_mfma_f32_16x16x32_bf16 v[24:27], v[140:143], v[128:131], v[24:27]
    ds_read_b128 v[100:103], v14 offset:30720
    ds_read_b128 v[104:107], v14 offset:31744
    v_mfma_f32_16x16x32_bf16 v[52:55], v[140:143], v[132:135], v[52:55]
    ds_read_b128 v[108:111], v14 offset:32768
    ds_read_b128 v[112:115], v14 offset:33792
    v_mfma_f32_16x16x32_bf16 v[28:31], v[144:147], v[128:131], v[28:31]
    ds_read_b128 v[116:119], v14 offset:34816
    ds_read_b128 v[120:123], v14 offset:35840
    v_mfma_f32_16x16x32_bf16 v[56:59], v[144:147], v[132:135], v[56:59]
    ds_read_b128 v[124:127], v14 offset:36864
    ds_read_b64_tr_b16 v[172:173], v168 offset:62720
    s_add_u32 s46, s46, 14336
    s_addc_u32 s47, s47, 0
    s_add_u32 m0, s12, 16384
    s_nop 0
    global_load_lds_dwordx4 v5, s[46:47] offset:0 sc1
    v_mfma_f32_16x16x32_bf16 v[32:35], v[148:151], v[128:131], v[32:35]
    ds_read_b64_tr_b16 v[174:175], v168 offset:63744
    ds_read_b64_tr_b16 v[176:177], v169 offset:62720
    v_mfma_f32_16x16x32_bf16 v[60:63], v[148:151], v[132:135], v[60:63]
    ds_read_b64_tr_b16 v[178:179], v169 offset:63744
    v_mfma_f32_16x16x32_bf16 v[36:39], v[152:155], v[128:131], v[36:39]
    s_add_u32 m0, s12, 0
    s_nop 0
    global_load_lds_dwordx4 v5, s[18:19] offset:1024 sc1
    v_mfma_f32_16x16x32_bf16 v[64:67], v[152:155], v[132:135], v[64:67]
    v_mfma_f32_16x16x32_bf16 v[40:43], v[156:159], v[128:131], v[40:43]
    v_mfma_f32_16x16x32_bf16 v[68:71], v[156:159], v[132:135], v[68:71]
    v_mfma_f32_16x16x32_bf16 v[44:47], v[160:163], v[128:131], v[44:47]
    s_add_u32 m0, s12, 16384
    s_nop 0
    global_load_lds_dwordx4 v5, s[46:47] offset:1024 sc1
    v_mfma_f32_16x16x32_bf16 v[72:75], v[160:163], v[132:135], v[72:75]
    s_waitcnt lgkmcnt(0)
    v_mfma_f32_16x16x32_bf16 v[76:79], v[16:19], v[172:175], 0
    ds_read_b64_tr_b16 v[128:129], v12 offset:38912
    v_mfma_f32_16x16x32_bf16 v[84:87], v[172:175], v[172:175], 0
    ds_read_b64_tr_b16 v[130:131], v12 offset:39936
    s_add_u32 m0, s12, 0
    s_nop 0
    global_load_lds_dwordx4 v5, s[18:19] offset:2048 sc1
    v_mfma_f32_16x16x32_bf16 v[80:83], v[16:19], v[176:179], 0
    ds_read_b64_tr_b16 v[132:133], v13 offset:38912
    v_mfma_f32_16x16x32_bf16 v[88:91], v[176:179], v[176:179], 0
    ds_read_b64_tr_b16 v[134:135], v13 offset:39936
    v_mfma_f32_16x16x32_bf16 v[20:23], v[100:103], v[92:95], v[20:23]
    ds_read_b128 v[136:139], v14 offset:37888
    v_mfma_f32_16x16x32_bf16 v[48:51], v[100:103], v[96:99], v[48:51]
    ds_read_b128 v[140:143], v14 offset:38912
    s_add_u32 m0, s12, 16384
    s_cmp_lt_u32 s10, 3
    s_cbranch_scc0 g1_skip_33
    global_load_lds_dwordx4 v5, s[46:47] offset:2048 sc1
    global_load_lds_dwordx4 v5, s[46:47] offset:3072 sc1
g1_skip_33:
    v_mfma_f32_16x16x32_bf16 v[24:27], v[104:107], v[92:95], v[24:27]
    ds_read_b128 v[144:147], v14 offset:39936
    v_cmp_eq_u32 s[38:39], 1, v1
    v_mfma_f32_16x16x32_bf16 v[52:55], v[104:107], v[96:99], v[52:55]
    ds_read_b128 v[148:151], v14 offset:40960
    v_cmp_eq_u32 s[40:41], 2, v1
    v_mfma_f32_16x16x32_bf16 v[28:31], v[108:111], v[92:95], v[28:31]
    ds_read_b128 v[152:155], v14 offset:41984
    v_cmp_eq_u32 s[42:43], 3, v1
    v_mfma_f32_16x16x32_bf16 v[56:59], v[108:111], v[96:99], v[56:59]
    ds_read_b128 v[156:159], v14 offset:43008
    v_cndmask_b32 v77, v84, v85, s[38:39]
    s_add_u32 m0, s12, 0
    s_nop 0
    global_load_lds_dwordx4 v5, s[18:19] offset:3072 sc1
    v_mfma_f32_16x16x32_bf16 v[32:35], v[112:115], v[92:95], v[32:35]
    ds_read_b128 v[160:163], v14 offset:44032
    v_cndmask_b32 v77, v77, v86, s[40:41]
    v_mfma_f32_16x16x32_bf16 v[60:63], v[112:115], v[96:99], v[60:63]
    v_cndmask_b32 v77, v77, v87, s[42:43]
    v_mfma_f32_16x16x32_bf16 v[36:39], v[116:119], v[92:95], v[36:39]
    v_cndmask_b32 v81, v88, v89, s[38:39]
    global_load_dword v164, v7, s[4:5] sc1
    v_mfma_f32_16x16x32_bf16 v[64:67], v[116:119], v[96:99], v[64:67]
    v_cndmask_b32 v81, v81, v90, s[40:41]
    v_mfma_f32_16x16x32_bf16 v[40:43], v[120:123], v[92:95], v[40:43]
    v_cndmask_b32 v81, v81, v91, s[42:43]
    v_mfma_f32_16x16x32_bf16 v[68:71], v[120:123], v[96:99], v[68:71]
    v_mfma_f32_16x16x32_bf16 v[44:47], v[124:127], v[92:95], v[44:47]
    v_add_u32 v7, 14336, v7
    global_load_dword v165, v7, s[4:5] sc1
    v_mfma_f32_16x16x32_bf16 v[72:75], v[124:127], v[96:99], v[72:75]
    s_waitcnt vmcnt(12) lgkmcnt(0)
    s_barrier
    s_cmp_eq_u32 s44, 2
    s_cbranch_scc0 g1_nx_34
    ds_read_b64_tr_b16 v[228:229], v15 offset:0
    ds_read_b64_tr_b16 v[230:231], v15 offset:1024
    ds_read_b64_tr_b16 v[232:233], v15 offset:8192
    ds_read_b64_tr_b16 v[234:235], v15 offset:9216
g1_nx_34:
    s_mov_b32 exec_lo, 0x00f0000f
    s_mov_b32 exec_hi, 0xf0000f00
    global_store_dwordx2 v11, v[76:77], s[4:5] sc1
    global_store_dwordx2 v11, v[80:81], s[4:5] offset:128 sc1
    s_mov_b64 exec, -1
    v_mfma_f32_16x16x32_bf16 v[20:23], v[136:139], v[128:131], v[20:23]
    ds_read_b64_tr_b16 v[92:93], v168 offset:0
    v_mfma_f32_16x16x32_bf16 v[48:51], v[136:139], v[132:135], v[48:51]
    ds_read_b64_tr_b16 v[94:95], v168 offset:1024
    s_add_u32 s18, s18, 16384
    s_addc_u32 s19, s19, 0
    s_add_u32 m0, s12, 30720
    s_nop 0
    global_load_lds_dwordx4 v5, s[18:19] offset:0 sc1
    v_mfma_f32_16x16x32_bf16 v[24:27], v[140:143], v[128:131], v[24:27]
    ds_read_b64_tr_b16 v[96:97], v169 offset:0
    v_mfma_f32_16x16x32_bf16 v[52:55], v[140:143], v[132:135], v[52:55]
    ds_read_b64_tr_b16 v[98:99], v169 offset:1024
    s_add_u32 s46, s46, 14336
    s_addc_u32 s47, s47, 0
    s_add_u32 m0, s12, 47104
    s_nop 0
    global_load_lds_dwordx4 v5, s[46:47] offset:0 sc1
    v_mfma_f32_16x16x32_bf16 v[28:31], v[144:147], v[128:131], v[28:31]
    ds_read_b128 v[100:103], v170 offset:0
    v_mfma_f32_16x16x32_bf16 v[56:59], v[144:147], v[132:135], v[56:59]
    ds_read_b128 v[104:107], v170 offset:1024
    s_add_u32 m0, s12, 30720
    s_nop 0
    global_load_lds_dwordx4 v5, s[18:19] offset:1024 sc1
    v_mfma_f32_16x16x32_bf16 v[32:35], v[148:151], v[128:131], v[32:35]
    ds_read_b128 v[108:111], v170 offset:2048
    v_mfma_f32_16x16x32_bf16 v[60:63], v[148:151], v[132:135], v[60:63]
    ds_read_b128 v[112:115], v170 offset:3072
    v_mfma_f32_16x16x32_bf16 v[36:39], v[152:155], v[128:131], v[36:39]
    ds_read_b128 v[116:119], v170 offset:4096
    s_add_u32 m0, s12, 47104
    s_nop 0
    global_load_lds_dwordx4 v5, s[46:47] offset:1024 sc1
    v_mfma_f32_16x16x32_bf16 v[64:67], v[152:155], v[132:135], v[64:67]
    ds_read_b128 v[120:123], v170 offset:5120
    v_mfma_f32_16x16x32_bf16 v[40:43], v[156:159], v[128:131], v[40:43]
    ds_read_b128 v[124:127], v170 offset:6144
    v_add_u32 v7, 14336, v7
    global_load_dword v166, v7, s[4:5] sc1
    v_mfma_f32_16x16x32_bf16 v[68:71], v[156:159], v[132:135], v[68:71]
    v_mfma_f32_16x16x32_bf16 v[44:47], v[160:163], v[128:131], v[44:47]
    v_add_u32 v7, 14336, v7
    global_load_dword v167, v7, s[4:5] sc1
    v_mfma_f32_16x16x32_bf16 v[72:75], v[160:163], v[132:135], v[72:75]
    s_waitcnt lgkmcnt(0)
    v_mfma_f32_16x16x32_bf16 v[20:23], v[100:103], v[92:95], v[20:23]
    ds_read_b64_tr_b16 v[128:129], v168 offset:8192
    v_mfma_f32_16x16x32_bf16 v[48:51], v[100:103], v[96:99], v[48:51]
    ds_read_b64_tr_b16 v[130:131], v168 offset:9216
    s_add_u32 m0, s12, 30720
    s_nop 0
    global_load_lds_dwordx4 v5, s[18:19] offset:2048 sc1
    v_mfma_f32_16x16x32_bf16 v[24:27], v[104:107], v[92:95], v[24:27]
    ds_read_b64_tr_b16 v[132:133], v169 offset:8192
    v_mfma_f32_16x16x32_bf16 v[52:55], v[104:107], v[96:99], v[52:55]
    ds_read_b64_tr_b16 v[134:135], v169 offset:9216
    v_mfma_f32_16x16x32_bf16 v[28:31], v[108:111], v[92:95], v[28:31]
    ds_read_b128 v[136:139], v170 offset:7168
    s_add_u32 m0, s12, 47104
    s_cmp_lt_u32 s10, 3
    s_cbranch_scc0 g1_skip_35
    global_load_lds_dwordx4 v5, s[46:47] offset:2048 sc1
    global_load_lds_dwordx4 v5, s[46:47] offset:3072 sc1
g1_skip_35:
    v_mfma_f32_16x16x32_bf16 v[56:59], v[108:111], v[96:99], v[56:59]
    ds_read_b128 v[140:143], v170 offset:8192
    v_mfma_f32_16x16x32_bf16 v[32:35], v[112:115], v[92:95], v[32:35]
    ds_read_b128 v[144:147], v170 offset:9216
    v_mfma_f32_16x16x32_bf16 v[60:63], v[112:115], v[96:99], v[60:63]
    ds_read_b128 v[148:151], v170 offset:10240
    s_add_u32 m0, s12, 30720
    s_nop 0
    global_load_lds_dwordx4 v5, s[18:19] offset:3072 sc1
    v_mfma_f32_16x16x32_bf16 v[36:39], v[116:119], v[92:95], v[36:39]
    ds_read_b128 v[152:155], v170 offset:11264
    v_mfma_f32_16x16x32_bf16 v[64:67], v[116:119], v[96:99], v[64:67]
    ds_read_b128 v[156:159], v170 offset:12288
    global_load_dword v180, v192, s[4:5] sc1
    v_mfma_f32_16x16x32_bf16 v[40:43], v[120:123], v[92:95], v[40:43]
    ds_read_b128 v[160:163], v170 offset:13312
    v_mfma_f32_16x16x32_bf16 v[68:71], v[120:123], v[96:99], v[68:71]
    v_mfma_f32_16x16x32_bf16 v[44:47], v[124:127], v[92:95], v[44:47]
    v_add_u32 v192, 12288, v192
    global_load_dword v181, v192, s[4:5] sc1
    v_mfma_f32_16x16x32_bf16 v[72:75], v[124:127], v[96:99], v[72:75]
    s_waitcnt vmcnt(10) lgkmcnt(0)
    s_barrier
    s_cmp_lg_u32 s10, 0
    s_cbranch_scc1 g_sig_36
    s_mov_b64 exec, 1
    global_atomic_add v253, v254, s[4:5] offset:0 sc1
    s_mov_b64 exec, -1
g_sig_36:
    s_cmp_eq_u32 s44, 3
    s_cbranch_scc0 g1_nx_37
    ds_read_b64_tr_b16 v[228:229], v15 offset:0
    ds_read_b64_tr_b16 v[230:231], v15 offset:1024
    ds_read_b64_tr_b16 v[232:233], v15 offset:8192
    ds_read_b64_tr_b16 v[234:235], v15 offset:9216
g1_nx_37:
    v_mfma_f32_16x16x32_bf16 v[20:23], v[136:139], v[128:131], v[20:23]
    ds_read_b64_tr_b16 v[92:93], v168 offset:30720
    v_mfma_f32_16x16x32_bf16 v[48:51], v[136:139], v[132:135], v[48:51]
    ds_read_b64_tr_b16 v[94:95], v168 offset:31744
    s_add_u32 s18, s18, 16384
    s_addc_u32 s19, s19, 0
    s_add_u32 m0, s12, 61440
    s_nop 0
    global_load_lds_dwordx4 v5, s[18:19] offset:0 sc1
    v_mfma_f32_16x16x32_bf16 v[24:27], v[140:143], v[128:131], v[24:27]
    ds_read_b64_tr_b16 v[96:97], v169 offset:30720
    v_mfma_f32_16x16x32_bf16 v[52:55], v[140:143], v[132:135], v[52:55]
    ds_read_b64_tr_b16 v[98:99], v169 offset:31744
    s_add_u32 s46, s46, 14336
    s_addc_u32 s47, s47, 0
    s_add_u32 m0, s12, 77824
    s_nop 0
    global_load_lds_dwordx4 v5, s[46:47] offset:0 sc1
    v_mfma_f32_16x16x32_bf16 v[28:31], v[144:147], v[128:131], v[28:31]
    ds_read_b128 v[100:103], v170 offset:30720
    v_mfma_f32_16x16x32_bf16 v[56:59], v[144:147], v[132:135], v[56:59]
    ds_read_b128 v[104:107], v170 offset:31744
    s_add_u32 m0, s12, 61440
    s_nop 0
    global_load_lds_dwordx4 v5, s[18:19] offset:1024 sc1
    v_mfma_f32_16x16x32_bf16 v[32:35], v[148:151], v[128:131], v[32:35]
    ds_read_b128 v[108:111], v170 offset:32768
    v_mfma_f32_16x16x32_bf16 v[60:63], v[148:151], v[132:135], v[60:63]
    ds_read_b128 v[112:115], v170 offset:33792
    v_mfma_f32_16x16x32_bf16 v[36:39], v[152:155], v[128:131], v[36:39]
    ds_read_b128 v[116:119], v170 offset:34816
    s_add_u32 m0, s12, 77824
    s_nop 0
    global_load_lds_dwordx4 v5, s[46:47] offset:1024 sc1
    v_mfma_f32_16x16x32_bf16 v[64:67], v[152:155], v[132:135], v[64:67]
    ds_read_b128 v[120:123], v170 offset:35840
    v_mfma_f32_16x16x32_bf16 v[40:43], v[156:159], v[128:131], v[40:43]
    ds_read_b128 v[124:127], v170 offset:36864
    v_add_u32 v192, 12288, v192
    global_load_dword v182, v192, s[4:5] sc1
    v_mfma_f32_16x16x32_bf16 v[68:71], v[156:159], v[132:135], v[68:71]
    v_mfma_f32_16x16x32_bf16 v[44:47], v[160:163], v[128:131], v[44:47]
    v_add_u32 v192, 12288, v192
    global_load_dword v183, v192, s[4:5] sc1
    v_mfma_f32_16x16x32_bf16 v[72:75], v[160:163], v[132:135], v[72:75]
    s_waitcnt lgkmcnt(0)
    v_mfma_f32_16x16x32_bf16 v[20:23], v[100:103], v[92:95], v[20:23]
    ds_read_b64_tr_b16 v[128:129], v168 offset:38912
    v_mfma_f32_16x16x32_bf16 v[48:51], v[100:103], v[96:99], v[48:51]
    ds_read_b64_tr_b16 v[130:131], v168 offset:39936
    v_mfma_f32_16x16x32_bf16 v[24:27], v[104:107], v[92:95], v[24:27]
    ds_read_b64_tr_b16 v[132:133], v169 offset:38912
    s_add_u32 m0, s12, 61440
    s_nop 0
    global_load_lds_dwordx4 v5, s[18:19] offset:2048 sc1
    v_mfma_f32_16x16x32_bf16 v[52:55], v[104:107], v[96:99], v[52:55]
    ds_read_b64_tr_b16 v[134:135], v169 offset:39936
    v_mfma_f32_16x16x32_bf16 v[28:31], v[108:111], v[92:95], v[28:31]
    ds_read_b128 v[136:139], v170 offset:37888
    v_mfma_f32_16x16x32_bf16 v[56:59], v[108:111], v[96:99], v[56:59]
    ds_read_b128 v[140:143], v170 offset:38912
    v_mfma_f32_16x16x32_bf16 v[32:35], v[112:115], v[92:95], v[32:35]
    ds_read_b128 v[144:147], v170 offset:39936
    v_mfma_f32_16x16x32_bf16 v[60:63], v[112:115], v[96:99], v[60:63]
    ds_read_b128 v[148:151], v170 offset:40960
    s_add_u32 m0, s12, 77824
    s_cmp_lt_u32 s10, 3
    s_cbranch_scc0 g1_skip_38
    global_load_lds_dwordx4 v5, s[46:47] offset:2048 sc1
    global_load_lds_dwordx4 v5, s[46:47] offset:3072 sc1
g1_skip_38:
    v_mfma_f32_16x16x32_bf16 v[36:39], v[116:119], v[92:95], v[36:39]
    ds_read_b128 v[152:155], v170 offset:41984
    v_mfma_f32_16x16x32_bf16 v[64:67], v[116:119], v[96:99], v[64:67]
    ds_read_b128 v[156:159], v170 offset:43008
    v_mfma_f32_16x16x32_bf16 v[40:43], v[120:123], v[92:95], v[40:43]
    ds_read_b128 v[160:163], v170 offset:44032
    v_mfma_f32_16x16x32_bf16 v[68:71], v[120:123], v[96:99], v[68:71]
    s_add_u32 m0, s12, 61440
    s_nop 0
    global_load_lds_dwordx4 v5, s[18:19] offset:3072 sc1
    v_mfma_f32_16x16x32_bf16 v[44:47], v[124:127], v[92:95], v[44:47]
    v_mfma_f32_16x16x32_bf16 v[72:75], v[124:127], v[96:99], v[72:75]
    s_waitcnt vmcnt(22) lgkmcnt(0)
    s_barrier
    s_cmp_eq_u32 s44, 4
    s_cbranch_scc0 g1_nx_39
    ds_read_b64_tr_b16 v[228:229], v15 offset:0
    ds_read_b64_tr_b16 v[230:231], v15 offset:1024
    ds_read_b64_tr_b16 v[232:233], v15 offset:8192
    ds_read_b64_tr_b16 v[234:235], v15 offset:9216
g1_nx_39:
    v_mfma_f32_16x16x32_bf16 v[20:23], v[136:139], v[128:131], v[20:23]
    ds_read_b64_tr_b16 v[92:93], v12 offset:0
    v_mfma_f32_16x16x32_bf16 v[48:51], v[136:139], v[132:135], v[48:51]
    ds_read_b64_tr_b16 v[94:95], v12 offset:1024
    s_add_u32 s18, s18, 16384
    s_addc_u32 s19, s19, 0
    s_add_u32 m0, s12, 92160
    s_nop 0
    global_load_lds_dwordx4 v5, s[18:19] offset:0 sc1
    v_mfma_f32_16x16x32_bf16 v[24:27], v[140:143], v[128:131], v[24:27]
    ds_read_b64_tr_b16 v[96:97], v13 offset:0
    v_mfma_f32_16x16x32_bf16 v[52:55], v[140:143], v[132:135], v[52:55]
    ds_read_b64_tr_b16 v[98:99], v13 offset:1024
    v_mfma_f32_16x16x32_bf16 v[28:31], v[144:147], v[128:131], v[28:31]
    ds_read_b128 v[100:103], v14 offset:0
    v_mfma_f32_16x16x32_bf16 v[56:59], v[144:147], v[132:135], v[56:59]
    ds_read_b128 v[104:107], v14 offset:1024
    s_add_u32 s46, s46, 14336
    s_addc_u32 s47, s47, 0
    s_add_u32 m0, s12, 108544
    s_nop 0
    global_load_lds_dwordx4 v5, s[46:47] offset:0 sc1
    v_mfma_f32_16x16x32_bf16 v[32:35], v[148:151], v[128:131], v[32:35]
    ds_read_b128 v[108:111], v14 offset:2048
    v_mfma_f32_16x16x32_bf16 v[60:63], v[148:151], v[132:135], v[60:63]
    ds_read_b128 v[112:115], v14 offset:3072
    v_mfma_f32_16x16x32_bf16 v[36:39], v[152:155], v[128:131], v[36:39]
    ds_read_b128 v[116:119], v14 offset:4096
    s_add_u32 m0, s12, 92160
    s_nop 0
    global_load_lds_dwordx4 v5, s[18:19] offset:1024 sc1
    v_mfma_f32_16x16x32_bf16 v[64:67], v[152:155], v[132:135], v[64:67]
    ds_read_b128 v[120:123], v14 offset:5120
    v_mfma_f32_16x16x32_bf16 v[40:43], v[156:159], v[128:131], v[40:43]
    ds_read_b128 v[124:127], v14 offset:6144
    v_mfma_f32_16x16x32_bf16 v[68:71], v[156:159], v[132:135], v[68:71]
    v_mfma_f32_16x16x32_bf16 v[44:47], v[160:163], v[128:131], v[44:47]
    s_add_u32 m0, s12, 108544
    s_nop 0
    global_load_lds_dwordx4 v5, s[46:47] offset:1024 sc1
    v_mfma_f32_16x16x32_bf16 v[72:75], v[160:163], v[132:135], v[72:75]
    s_waitcnt lgkmcnt(0)
    global_load_dword v171, v253, s[4:5] offset:0 sc1
    v_mfma_f32_16x16x32_bf16 v[20:23], v[100:103], v[92:95], v[20:23]
    ds_read_b64_tr_b16 v[128:129], v12 offset:8192
    v_mfma_f32_16x16x32_bf16 v[48:51], v[100:103], v[96:99], v[48:51]
    ds_read_b64_tr_b16 v[130:131], v12 offset:9216
    v_mfma_f32_16x16x32_bf16 v[24:27], v[104:107], v[92:95], v[24:27]
    ds_read_b64_tr_b16 v[132:133], v13 offset:8192
    s_add_u32 m0, s12, 92160
    s_nop 0
    global_load_lds_dwordx4 v5, s[18:19] offset:2048 sc1
    v_mfma_f32_16x16x32_bf16 v[52:55], v[104:107], v[96:99], v[52:55]
    ds_read_b64_tr_b16 v[134:135], v13 offset:9216
    v_mfma_f32_16x16x32_bf16 v[28:31], v[108:111], v[92:95], v[28:31]
    ds_read_b128 v[136:139], v14 offset:7168
    v_mfma_f32_16x16x32_bf16 v[56:59], v[108:111], v[96:99], v[56:59]
    ds_read_b128 v[140:143], v14 offset:8192
    v_mfma_f32_16x16x32_bf16 v[32:35], v[112:115], v[92:95], v[32:35]
    ds_read_b128 v[144:147], v14 offset:9216
    v_mfma_f32_16x16x32_bf16 v[60:63], v[112:115], v[96:99], v[60:63]
    ds_read_b128 v[148:151], v14 offset:10240
    s_add_u32 m0, s12, 108544
    s_cmp_lt_u32 s10, 3
    s_cbranch_scc0 g1_skip_40
    global_load_lds_dwordx4 v5, s[46:47] offset:2048 sc1
    global_load_lds_dwordx4 v5, s[46:47] offset:3072 sc1
g1_skip_40:
    v_mfma_f32_16x16x32_bf16 v[36:39], v[116:119], v[92:95], v[36:39]
    ds_read_b128 v[152:155], v14 offset:11264
    v_mfma_f32_16x16x32_bf16 v[64:67], v[116:119], v[96:99], v[64:67]
    ds_read_b128 v[156:159], v14 offset:12288
    v_mfma_f32_16x16x32_bf16 v[40:43], v[120:123], v[92:95], v[40:43]
    ds_read_b128 v[160:163], v14 offset:13312
    v_mfma_f32_16x16x32_bf16 v[68:71], v[120:123], v[96:99], v[68:71]
    s_add_u32 m0, s12, 92160
    s_nop 0
    global_load_lds_dwordx4 v5, s[18:19] offset:3072 sc1
    v_mfma_f32_16x16x32_bf16 v[44:47], v[124:127], v[92:95], v[44:47]
    v_mfma_f32_16x16x32_bf16 v[72:75], v[124:127], v[96:99], v[72:75]
    s_waitcnt vmcnt(17) lgkmcnt(0)
    s_barrier
    s_cmp_eq_u32 s44, 5
    s_cbranch_scc0 g1_nx_41
    ds_read_b64_tr_b16 v[228:229], v15 offset:0
    ds_read_b64_tr_b16 v[230:231], v15 offset:1024
    ds_read_b64_tr_b16 v[232:233], v15 offset:8192
    ds_read_b64_tr_b16 v[234:235], v15 offset:9216
g1_nx_41:
    v_mfma_f32_16x16x32_bf16 v[20:23], v[136:139], v[128:131], v[20:23]
    ds_read_b64_tr_b16 v[92:93], v12 offset:30720
    v_mfma_f32_16x16x32_bf16 v[48:51], v[136:139], v[132:135], v[48:51]
    ds_read_b64_tr_b16 v[94:95], v12 offset:31744
    global_load_dwordx4 a[40:43], v252, s[52:53] offset:2048 sc1
    v_mfma_f32_16x16x32_bf16 v[24:27], v[140:143], v[128:131], v[24:27]
    ds_read_b64_tr_b16 v[96:97], v13 offset:30720
    v_mfma_f32_16x16x32_bf16 v[52:55], v[140:143], v[132:135], v[52:55]
    ds_read_b64_tr_b16 v[98:99], v13 offset:31744
    v_mfma_f32_16x16x32_bf16 v[28:31], v[144:147], v[128:131], v[28:31]
    ds_read_b128 v[100:103], v14 offset:30720
    v_mfma_f32_16x16x32_bf16 v[56:59], v[144:147], v[132:135], v[56:59]
    ds_read_b128 v[104:107], v14 offset:31744
    global_load_dwordx4 a[44:47], v252, s[52:53] offset:3072 sc1
    v_mfma_f32_16x16x32_bf16 v[32:35], v[148:151], v[128:131], v[32:35]
    ds_read_b128 v[108:111], v14 offset:32768
    v_mfma_f32_16x16x32_bf16 v[60:63], v[148:151], v[132:135], v[60:63]
    ds_read_b128 v[112:115], v14 offset:33792
    v_mfma_f32_16x16x32_bf16 v[36:39], v[152:155], v[128:131], v[36:39]
    ds_read_b128 v[116:119], v14 offset:34816
    s_add_u32 s52, s52, 4096
    s_addc_u32 s53, s53, 0
    global_load_dwordx4 a[48:51], v252, s[52:53] offset:0 sc1
    v_mfma_f32_16x16x32_bf16 v[64:67], v[152:155], v[132:135], v[64:67]
    ds_read_b128 v[120:123], v14 offset:35840
    v_mfma_f32_16x16x32_bf16 v[40:43], v[156:159], v[128:131], v[40:43]
    ds_read_b128 v[124:127], v14 offset:36864
    v_mfma_f32_16x16x32_bf16 v[68:71], v[156:159], v[132:135], v[68:71]
    v_mfma_f32_16x16x32_bf16 v[44:47], v[160:163], v[128:131], v[44:47]
    global_load_dwordx4 a[52:55], v252, s[52:53] offset:1024 sc1
    v_mfma_f32_16x16x32_bf16 v[72:75], v[160:163], v[132:135], v[72:75]
    s_waitcnt lgkmcnt(0)
    s_waitcnt vmcnt(6)
    s_mov_b32 s14, 200000
g_poll_43:
    v_readfirstlane_b32 s15, v171
    s_nop 1
    s_cmp_ge_u32 s15, 16
    s_cbranch_scc1 g_go_42
    s_sleep 1
    global_load_dword v171, v253, s[4:5] offset:0 sc1
    s_sub_u32 s14, s14, 1
    s_cmp_lg_u32 s14, 0
    s_waitcnt vmcnt(0)
    s_cbranch_scc1 g_poll_43
g_go_42:
    v_mfma_f32_16x16x32_bf16 v[20:23], v[100:103], v[92:95], v[20:23]
    ds_read_b64_tr_b16 v[128:129], v12 offset:38912
    global_load_dwordx2 v[76:77], v191, s[4:5] offset:0 sc1
    v_mfma_f32_16x16x32_bf16 v[48:51], v[100:103], v[96:99], v[48:51]
    ds_read_b64_tr_b16 v[130:131], v12 offset:39936
    global_load_dwordx2 v[78:79], v191, s[4:5] offset:1024 sc1
    v_mfma_f32_16x16x32_bf16 v[24:27], v[104:107], v[92:95], v[24:27]
    ds_read_b64_tr_b16 v[132:133], v13 offset:38912
    global_load_dwordx2 v[80:81], v191, s[4:5] offset:2048 sc1
    v_mfma_f32_16x16x32_bf16 v[52:55], v[104:107], v[96:99], v[52:55]
    ds_read_b64_tr_b16 v[134:135], v13 offset:39936
    v_mfma_f32_16x16x32_bf16 v[28:31], v[108:111], v[92:95], v[28:31]
    ds_read_b128 v[136:139], v14 offset:37888
    global_load_dwordx2 v[82:83], v191, s[4:5] offset:3072 sc1
    v_mfma_f32_16x16x32_bf16 v[56:59], v[108:111], v[96:99], v[56:59]
    ds_read_b128 v[140:143], v14 offset:38912
    global_load_dwordx2 v[84:85], v191, s[4:5] offset:128 sc1
    v_mfma_f32_16x16x32_bf16 v[32:35], v[112:115], v[92:95], v[32:35]
    ds_read_b128 v[144:147], v14 offset:39936
    global_load_dwordx2 v[86:87], v191, s[4:5] offset:1152 sc1
    v_mfma_f32_16x16x32_bf16 v[60:63], v[112:115], v[96:99], v[60:63]
    ds_read_b128 v[148:151], v14 offset:40960
    global_load_dwordx2 v[88:89], v191, s[4:5] offset:2176 sc1
    v_mfma_f32_16x16x32_bf16 v[36:39], v[116:119], v[92:95], v[36:39]
    ds_read_b128 v[152:155], v14 offset:41984
    global_load_dwordx2 v[90:91], v191, s[4:5] offset:3200 sc1
    v_mfma_f32_16x16x32_bf16 v[64:67], v[116:119], v[96:99], v[64:67]
    ds_read_b128 v[156:159], v14 offset:43008
    global_load_dwordx4 a[56:59], v252, s[52:53] offset:2048 sc1
    v_mfma_f32_16x16x32_bf16 v[40:43], v[120:123], v[92:95], v[40:43]
    ds_read_b128 v[160:163], v14 offset:44032
    v_mfma_f32_16x16x32_bf16 v[68:71], v[120:123], v[96:99], v[68:71]
    global_load_dwordx4 a[60:63], v252, s[52:53] offset:3072 sc1
    v_mfma_f32_16x16x32_bf16 v[44:47], v[124:127], v[92:95], v[44:47]
    s_add_u32 s52, s52, 4096
    s_addc_u32 s53, s53, 0
    global_load_dwordx4 a[64:67], v252, s[52:53] offset:0 sc1
    v_mfma_f32_16x16x32_bf16 v[72:75], v[124:127], v[96:99], v[72:75]
    global_load_dwordx4 a[68:71], v252, s[52:53] offset:1024 sc1
    s_waitcnt vmcnt(23) lgkmcnt(0)
    s_barrier
    s_cmp_eq_u32 s44, 6
    s_cbranch_scc0 g1_nx_44
    ds_read_b64_tr_b16 v[228:229], v15 offset:0
    ds_read_b64_tr_b16 v[230:231], v15 offset:1024
    ds_read_b64_tr_b16 v[232:233], v15 offset:8192
    ds_read_b64_tr_b16 v[234:235], v15 offset:9216
g1_nx_44:
    v_mfma_f32_16x16x32_bf16 v[20:23], v[136:139], v[128:131], v[20:23]
    ds_read_b64_tr_b16 v[92:93], v168 offset:0
    v_add_f32 v164, v164, v165
    v_add_f32 v166, v166, v167
    v_mfma_f32_16x16x32_bf16 v[48:51], v[136:139], v[132:135], v[48:51]
    ds_read_b64_tr_b16 v[94:95], v168 offset:1024
    v_add_f32 v164, v164, v166
    ds_write_b32 v8, v164
    global_load_dwordx4 a[72:75], v252, s[52:53] offset:2048 sc1
    v_mfma_f32_16x16x32_bf16 v[24:27], v[140:143], v[128:131], v[24:27]
    ds_read_b64_tr_b16 v[96:97], v169 offset:0
    v_add_f32 v180, v180, v181
    v_add_f32 v180, v180, v182
    v_mfma_f32_16x16x32_bf16 v[52:55], v[140:143], v[132:135], v[52:55]
    ds_read_b64_tr_b16 v[98:99], v169 offset:1024
    v_add_f32 v180, v180, v183
    v_cvt_pk_bf16_f32 v180, v180, v180
    v_mfma_f32_16x16x32_bf16 v[28:31], v[144:147], v[128:131], v[28:31]
    ds_read_b128 v[100:103], v170 offset:0
    v_and_b32 v180, 0xffff0000, v180
    v_bfe_u32 v192, v2, 1, 4
    v_mfma_f32_16x16x32_bf16 v[56:59], v[144:147], v[132:135], v[56:59]
    ds_read_b128 v[104:107], v170 offset:1024
    v_and_b32 v181, 1, v2
    v_lshl_add_u32 v192, v181, 4, v192
    global_load_dwordx4 a[76:79], v252, s[52:53] offset:3072 sc1
    v_mfma_f32_16x16x32_bf16 v[32:35], v[148:151], v[128:131], v[32:35]
    ds_read_b128 v[108:111], v170 offset:2048
    v_and_b32 v181, 32, v2
    v_add_u32 v192, v192, v181
    v_mfma_f32_16x16x32_bf16 v[60:63], v[148:151], v[132:135], v[60:63]
    ds_read_b128 v[112:115], v170 offset:3072
    v_lshlrev_b32 v192, 2, v192
    v_add_u32 v192, 123904, v192
    v_mfma_f32_16x16x32_bf16 v[36:39], v[152:155], v[128:131], v[36:39]
    ds_read_b128 v[116:119], v170 offset:4096
    ds_write_b32 v192, v180
    v_lshlrev_b32 v7, 4, v4
    s_add_u32 s52, s52, 4096
    s_addc_u32 s53, s53, 0
    global_load_dwordx4 a[80:83], v252, s[52:53] offset:0 sc1
    v_mfma_f32_16x16x32_bf16 v[64:67], v[152:155], v[132:135], v[64:67]
    ds_read_b128 v[120:123], v170 offset:5120
    v_add_u32 v7, 122880, v7
    v_mfma_f32_16x16x32_bf16 v[40:43], v[156:159], v[128:131], v[40:43]
    ds_read_b128 v[124:127], v170 offset:6144
    v_mfma_f32_16x16x32_bf16 v[68:71], v[156:159], v[132:135], v[68:71]
    v_mfma_f32_16x16x32_bf16 v[44:47], v[160:163], v[128:131], v[44:47]
    global_load_dwordx4 a[84:87], v252, s[52:53] offset:1024 sc1
    v_mfma_f32_16x16x32_bf16 v[72:75], v[160:163], v[132:135], v[72:75]
    s_waitcnt lgkmcnt(0)
    v_mfma_f32_16x16x32_bf16 v[20:23], v[100:103], v[92:95], v[20:23]
    ds_read_b64_tr_b16 v[128:129], v168 offset:8192
    v_mfma_f32_16x16x32_bf16 v[48:51], v[100:103], v[96:99], v[48:51]
    ds_read_b64_tr_b16 v[130:131], v168 offset:9216
    global_load_dwordx4 a[88:91], v252, s[52:53] offset:2048 sc1
    v_mfma_f32_16x16x32_bf16 v[24:27], v[104:107], v[92:95], v[24:27]
    ds_read_b64_tr_b16 v[132:133], v169 offset:8192
    v_mfma_f32_16x16x32_bf16 v[52:55], v[104:107], v[96:99], v[52:55]
    ds_read_b64_tr_b16 v[134:135], v169 offset:9216
    v_mfma_f32_16x16x32_bf16 v[28:31], v[108:111], v[92:95], v[28:31]
    ds_read_b128 v[136:139], v170 offset:7168
    v_mfma_f32_16x16x32_bf16 v[56:59], v[108:111], v[96:99], v[56:59]
    ds_read_b128 v[140:143], v170 offset:8192
    global_load_dwordx4 a[92:95], v252, s[52:53] offset:3072 sc1
    v_mfma_f32_16x16x32_bf16 v[32:35], v[112:115], v[92:95], v[32:35]
    ds_read_b128 v[144:147], v170 offset:9216
    v_mfma_f32_16x16x32_bf16 v[60:63], v[112:115], v[96:99], v[60:63]
    ds_read_b128 v[148:151], v170 offset:10240
    v_mfma_f32_16x16x32_bf16 v[36:39], v[116:119], v[92:95], v[36:39]
    ds_read_b128 v[152:155], v170 offset:11264
    s_add_u32 s52, s52, 4096
    s_addc_u32 s53, s53, 0
    global_load_dwordx4 a[96:99], v252, s[52:53] offset:0 sc1
    v_mfma_f32_16x16x32_bf16 v[64:67], v[116:119], v[96:99], v[64:67]
    ds_read_b128 v[156:159], v170 offset:12288
    v_mfma_f32_16x16x32_bf16 v[40:43], v[120:123], v[92:95], v[40:43]
    ds_read_b128 v[160:163], v170 offset:13312
    v_mfma_f32_16x16x32_bf16 v[68:71], v[120:123], v[96:99], v[68:71]
    v_mfma_f32_16x16x32_bf16 v[44:47], v[124:127], v[92:95], v[44:47]
    global_load_dwordx4 a[100:103], v252, s[52:53] offset:1024 sc1
    v_mfma_f32_16x16x32_bf16 v[72:75], v[124:127], v[96:99], v[72:75]
    s_waitcnt vmcnt(24) lgkmcnt(0)
    s_barrier
    s_cmp_eq_u32 s44, 7
    s_cbranch_scc0 g1_nx_45
    ds_read_b64_tr_b16 v[228:229], v15 offset:0
    ds_read_b64_tr_b16 v[230:231], v15 offset:1024
    ds_read_b64_tr_b16 v[232:233], v15 offset:8192
    ds_read_b64_tr_b16 v[234:235], v15 offset:9216
g1_nx_45:
    s_waitcnt vmcnt(12)
    v_mfma_f32_16x16x32_bf16 v[20:23], v[136:139], v[128:131], v[20:23]
    ds_read_b64_tr_b16 v[92:93], v168 offset:30720
    ds_read_b64_tr_b16 v[94:95], v168 offset:31744
    v_add_f32 v76, v76, v78
    v_add_f32 v80, v80, v82
    v_mfma_f32_16x16x32_bf16 v[48:51], v[136:139], v[132:135], v[48:51]
    ds_read_b64_tr_b16 v[96:97], v169 offset:30720
    ds_read_b64_tr_b16 v[98:99], v169 offset:31744
    v_add_f32 v77, v77, v79
    v_add_f32 v81, v81, v83
    global_load_dwordx4 a[104:107], v252, s[52:53] offset:2048 sc1
    v_mfma_f32_16x16x32_bf16 v[24:27], v[140:143], v[128:131], v[24:27]
    ds_read_b128 v[100:103], v170 offset:30720
    ds_read_b128 v[104:107], v170 offset:31744
    v_add_f32 v84, v84, v86
    v_add_f32 v88, v88, v90
    v_mfma_f32_16x16x32_bf16 v[52:55], v[140:143], v[132:135], v[52:55]
    ds_read_b128 v[108:111], v170 offset:32768
    ds_read_b128 v[112:115], v170 offset:33792
    v_add_f32 v85, v85, v87
    v_add_f32 v89, v89, v91
    v_mfma_f32_16x16x32_bf16 v[28:31], v[144:147], v[128:131], v[28:31]
    ds_read_b128 v[116:119], v170 offset:34816
    ds_read_b128 v[120:123], v170 offset:35840
    v_add_f32 v76, v76, v80
    v_add_f32 v77, v77, v81
    v_mfma_f32_16x16x32_bf16 v[56:59], v[144:147], v[132:135], v[56:59]
    ds_read_b128 v[124:127], v170 offset:36864
    ds_read_b128 v[172:175], v7 offset:0
    v_add_f32 v84, v84, v88
    v_add_f32 v85, v85, v89
    global_load_dwordx4 a[108:111], v252, s[52:53] offset:3072 sc1
    v_mfma_f32_16x16x32_bf16 v[32:35], v[148:151], v[128:131], v[32:35]
    ds_read_b128 v[176:179], v7 offset:64
    ds_read_b128 v[180:183], v7 offset:128
    v_mov_b32 v78, v76
    v_mov_b32 v79, v77
    v_mfma_f32_16x16x32_bf16 v[60:63], v[148:151], v[132:135], v[60:63]
    ds_read_b128 v[184:187], v7 offset:192
    ds_read_b128 v[188:191], v7 offset:256
    v_mov_b32 v86, v84
    v_mov_b32 v87, v85
    v_mfma_f32_16x16x32_bf16 v[36:39], v[152:155], v[128:131], v[36:39]
    ds_read_b128 v[192:195], v7 offset:320
    ds_read_b128 v[196:199], v7 offset:384
    v_permlane16_swap_b32 v76, v78
    v_permlane16_swap_b32 v77, v79
    s_add_u32 s52, s50, s55
    s_addc_u32 s53, s51, 0
    global_load_dwordx4 a[112:115], v252, s[52:53] offset:0 sc1
    v_mfma_f32_16x16x32_bf16 v[64:67], v[152:155], v[132:135], v[64:67]
    v_permlane16_swap_b32 v84, v86
    v_permlane16_swap_b32 v85, v87
    v_mfma_f32_16x16x32_bf16 v[40:43], v[156:159], v[128:131], v[40:43]
    v_add_f32 v76, v76, v78
    v_add_f32 v77, v77, v79
    v_mfma_f32_16x16x32_bf16 v[68:71], v[156:159], v[132:135], v[68:71]
    v_add_f32 v84, v84, v86
    v_mfma_f32_16x16x32_bf16 v[44:47], v[160:163], v[128:131], v[44:47]
    global_load_dwordx4 a[116:119], v252, s[52:53] offset:1024 sc1
    v_mfma_f32_16x16x32_bf16 v[72:75], v[160:163], v[132:135], v[72:75]
    s_waitcnt lgkmcnt(0)
    v_mfma_f32_16x16x32_bf16 v[20:23], v[100:103], v[92:95], v[20:23]
    ds_read_b64_tr_b16 v[128:129], v168 offset:38912
    v_add_f32 v85, v85, v87
    v_mov_b32 v78, v76
    v_mfma_f32_16x16x32_bf16 v[48:51], v[100:103], v[96:99], v[48:51]
    ds_read_b64_tr_b16 v[130:131], v168 offset:39936
    v_mov_b32 v79, v77
    v_mov_b32 v86, v84
    global_load_dwordx4 a[120:123], v252, s[52:53] offset:2048 sc1
    v_mfma_f32_16x16x32_bf16 v[24:27], v[104:107], v[92:95], v[24:27]
    ds_read_b64_tr_b16 v[132:133], v169 offset:38912
    v_mov_b32 v87, v85
    v_permlane32_swap_b32 v76, v78
    v_mfma_f32_16x16x32_bf16 v[52:55], v[104:107], v[96:99], v[52:55]
    ds_read_b64_tr_b16 v[134:135], v169 offset:39936
    v_permlane32_swap_b32 v77, v79
    v_permlane32_swap_b32 v84, v86
    v_mfma_f32_16x16x32_bf16 v[28:31], v[108:111], v[92:95], v[28:31]
    ds_read_b128 v[136:139], v170 offset:37888
    v_permlane32_swap_b32 v85, v87
    v_add_f32 v76, v76, v78
    v_mfma_f32_16x16x32_bf16 v[56:59], v[108:111], v[96:99], v[56:59]
    ds_read_b128 v[140:143], v170 offset:38912
    v_add_f32 v77, v77, v79
    v_add_f32 v84, v84, v86
    global_load_dwordx4 a[124:127], v252, s[52:53] offset:3072 sc1
    v_mfma_f32_16x16x32_bf16 v[32:35], v[112:115], v[92:95], v[32:35]
    ds_read_b128 v[144:147], v170 offset:39936
    v_add_f32 v85, v85, v87
    v_mul_f32 v76, 0x3b000000, v76
    v_mfma_f32_16x16x32_bf16 v[60:63], v[112:115], v[96:99], v[60:63]
    ds_read_b128 v[148:151], v170 offset:40960
    v_mul_f32 v84, 0x3b000000, v84
    v_mul_f32 v77, 0x3b000000, v77
    v_mfma_f32_16x16x32_bf16 v[36:39], v[116:119], v[92:95], v[36:39]
    ds_read_b128 v[152:155], v170 offset:41984
    v_mul_f32 v85, 0x3b000000, v85
    v_fma_f32 v78, -v76, v76, v77
    s_add_u32 s52, s52, 4096
    s_addc_u32 s53, s53, 0
    global_load_dwordx4 a[128:131], v252, s[52:53] offset:0 sc1
    v_mfma_f32_16x16x32_bf16 v[64:67], v[116:119], v[96:99], v[64:67]
    ds_read_b128 v[156:159], v170 offset:43008
    v_fma_f32 v86, -v84, v84, v85
    v_max_f32 v78, 0, v78
    v_mfma_f32_16x16x32_bf16 v[40:43], v[120:123], v[92:95], v[40:43]
    ds_read_b128 v[160:163], v170 offset:44032
    v_max_f32 v86, 0, v86
    v_cvt_pk_bf16_f32 v78, v78, v78
    v_mfma_f32_16x16x32_bf16 v[68:71], v[120:123], v[96:99], v[68:71]
    ds_read_b128 v[200:203], v7 offset:448
    v_cvt_pk_bf16_f32 v86, v86, v86
    v_mfma_f32_16x16x32_bf16 v[44:47], v[124:127], v[92:95], v[44:47]
    ds_read_b128 v[204:207], v7 offset:512
    global_load_dwordx4 a[132:135], v252, s[52:53] offset:1024 sc1
    v_mfma_f32_16x16x32_bf16 v[72:75], v[124:127], v[96:99], v[72:75]
    ds_read_b128 v[208:211], v7 offset:576
    s_waitcnt lgkmcnt(0)
    v_mfma_f32_16x16x32_bf16 v[20:23], v[136:139], v[128:131], v[20:23]
    ds_read_b128 v[212:215], v7 offset:640
    v_and_b32 v78, 0xffff0000, v78
    v_and_b32 v86, 0xffff0000, v86
    v_mfma_f32_16x16x32_bf16 v[48:51], v[136:139], v[132:135], v[48:51]
    ds_read_b128 v[216:219], v7 offset:704
    v_add_f32 v78, 0x3727c5ac, v78
    v_add_f32 v86, 0x3727c5ac, v86
    global_load_dwordx4 a[136:139], v252, s[52:53] offset:2048 sc1
    v_mfma_f32_16x16x32_bf16 v[24:27], v[140:143], v[128:131], v[24:27]
    ds_read_b128 v[220:223], v7 offset:768
    v_cvt_pk_bf16_f32 v78, v78, v78
    v_cvt_pk_bf16_f32 v86, v86, v86
    v_mfma_f32_16x16x32_bf16 v[52:55], v[140:143], v[132:135], v[52:55]
    ds_read_b128 v[224:227], v7 offset:832
    v_and_b32 v78, 0xffff0000, v78
    v_and_b32 v86, 0xffff0000, v86
    v_mfma_f32_16x16x32_bf16 v[28:31], v[144:147], v[128:131], v[28:31]
    ds_read_b128 v[236:239], v7 offset:1024
    v_sqrt_f32 v78, v78
    v_sqrt_f32 v86, v86
    v_mfma_f32_16x16x32_bf16 v[56:59], v[144:147], v[132:135], v[56:59]
    ds_read_b128 v[240:243], v7 offset:1088
    v_cvt_pk_bf16_f32 v16, v76, v76
    v_cvt_pk_bf16_f32 v18, v84, v84
    global_load_dwordx4 a[140:143], v252, s[52:53] offset:3072 sc1
    v_mfma_f32_16x16x32_bf16 v[32:35], v[148:151], v[128:131], v[32:35]
    ds_read_b128 v[244:247], v7 offset:1152
    v_and_b32 v16, 0xffff0000, v16
    v_and_b32 v18, 0xffff0000, v18
    v_mfma_f32_16x16x32_bf16 v[60:63], v[148:151], v[132:135], v[60:63]
    ds_read_b128 v[248:251], v7 offset:1216
    v_cvt_pk_bf16_f32 v78, v78, v78
    v_cvt_pk_bf16_f32 v86, v86, v86
    v_mfma_f32_16x16x32_bf16 v[36:39], v[152:155], v[128:131], v[36:39]
    v_and_b32 v78, 0xffff0000, v78
    v_and_b32 v86, 0xffff0000, v86
    s_add_u32 s52, s52, 4096
    s_addc_u32 s53, s53, 0
    global_load_dwordx4 a[144:147], v252, s[52:53] offset:0 sc1
    v_mfma_f32_16x16x32_bf16 v[64:67], v[152:155], v[132:135], v[64:67]
    v_rcp_f32 v17, v78
    v_rcp_f32 v19, v86
    v_mfma_f32_16x16x32_bf16 v[40:43], v[156:159], v[128:131], v[40:43]
    v_mul_f32 v17, s34, v17
    v_mul_f32 v19, s34, v19
    v_mfma_f32_16x16x32_bf16 v[68:71], v[156:159], v[132:135], v[68:71]
    v_mfma_f32_16x16x32_bf16 v[44:47], v[160:163], v[128:131], v[44:47]
    global_load_dwordx4 a[148:151], v252, s[52:53] offset:1024 sc1
    v_mfma_f32_16x16x32_bf16 v[72:75], v[160:163], v[132:135], v[72:75]
    s_waitcnt lgkmcnt(0)
    s_nop 6
    v_pk_fma_f32 v[20:21], v[172:173], v[16:17], v[20:21] op_sel:[0,0,0] op_sel_hi:[1,0,1] neg_lo:[1,0,0] neg_hi:[1,0,0]
    v_pk_fma_f32 v[22:23], v[174:175], v[16:17], v[22:23] op_sel:[0,0,0] op_sel_hi:[1,0,1] neg_lo:[1,0,0] neg_hi:[1,0,0]
    v_pk_fma_f32 v[20:21], v[20:21], v[16:17], v[200:201] op_sel:[0,1,0] op_sel_hi:[1,1,1]
    v_pk_fma_f32 v[22:23], v[22:23], v[16:17], v[202:203] op_sel:[0,1,0] op_sel_hi:[1,1,1]
    v_exp_f32 v124, -v20
    v_exp_f32 v125, -v21
    v_exp_f32 v126, -v22
    v_exp_f32 v127, -v23
    v_pk_fma_f32 v[124:125], v[124:125], s[34:35], s[34:35]
    v_pk_fma_f32 v[126:127], v[126:127], s[34:35], s[34:35]
    v_rcp_f32 v124, v124
    v_rcp_f32 v125, v125
    v_rcp_f32 v126, v126
    v_rcp_f32 v127, v127
    v_pk_mul_f32 v[20:21], v[20:21], v[124:125]
    v_pk_mul_f32 v[22:23], v[22:23], v[126:127]
    v_cvt_pk_bf16_f32 v92, v20, v21
    v_cvt_pk_bf16_f32 v93, v22, v23
    v_pk_fma_f32 v[24:25], v[176:177], v[16:17], v[24:25] op_sel:[0,0,0] op_sel_hi:[1,0,1] neg_lo:[1,0,0] neg_hi:[1,0,0]
    v_pk_fma_f32 v[26:27], v[178:179], v[16:17], v[26:27] op_sel:[0,0,0] op_sel_hi:[1,0,1] neg_lo:[1,0,0] neg_hi:[1,0,0]
    v_pk_fma_f32 v[24:25], v[24:25], v[16:17], v[204:205] op_sel:[0,1,0] op_sel_hi:[1,1,1]
    v_pk_fma_f32 v[26:27], v[26:27], v[16:17], v[206:207] op_sel:[0,1,0] op_sel_hi:[1,1,1]
    v_exp_f32 v128, -v24
    v_exp_f32 v129, -v25
    v_exp_f32 v130, -v26
    v_exp_f32 v131, -v27
    v_pk_fma_f32 v[128:129], v[128:129], s[34:35], s[34:35]
    v_pk_fma_f32 v[130:131], v[130:131], s[34:35], s[34:35]
    v_rcp_f32 v128, v128
    v_rcp_f32 v129, v129
    v_rcp_f32 v130, v130
    v_rcp_f32 v131, v131
    v_pk_mul_f32 v[24:25], v[24:25], v[128:129]
    v_pk_mul_f32 v[26:27], v[26:27], v[130:131]
    v_cvt_pk_bf16_f32 v94, v24, v25
    v_cvt_pk_bf16_f32 v95, v26, v27
    global_store_dwordx4 v9, v[92:95], s[4:5] offset:0 sc1
    v_pk_fma_f32 v[48:49], v[172:173], v[18:19], v[48:49] op_sel:[0,0,0] op_sel_hi:[1,0,1] neg_lo:[1,0,0] neg_hi:[1,0,0]
    v_pk_fma_f32 v[50:51], v[174:175], v[18:19], v[50:51] op_sel:[0,0,0] op_sel_hi:[1,0,1] neg_lo:[1,0,0] neg_hi:[1,0,0]
    v_pk_fma_f32 v[48:49], v[48:49], v[18:19], v[200:201] op_sel:[0,1,0] op_sel_hi:[1,1,1]
    v_pk_fma_f32 v[50:51], v[50:51], v[18:19], v[202:203] op_sel:[0,1,0] op_sel_hi:[1,1,1]
    v_exp_f32 v124, -v48
    v_exp_f32 v125, -v49
    v_exp_f32 v126, -v50
    v_exp_f32 v127, -v51
    v_pk_fma_f32 v[124:125], v[124:125], s[34:35], s[34:35]
    v_pk_fma_f32 v[126:127], v[126:127], s[34:35], s[34:35]
    v_rcp_f32 v124, v124
    v_rcp_f32 v125, v125
    v_rcp_f32 v126, v126
    v_rcp_f32 v127, v127
    v_pk_mul_f32 v[48:49], v[48:49], v[124:125]
    v_pk_mul_f32 v[50:51], v[50:51], v[126:127]
    v_cvt_pk_bf16_f32 v96, v48, v49
    v_cvt_pk_bf16_f32 v97, v50, v51
    v_pk_fma_f32 v[52:53], v[176:177], v[18:19], v[52:53] op_sel:[0,0,0] op_sel_hi:[1,0,1] neg_lo:[1,0,0] neg_hi:[1,0,0]
    v_pk_fma_f32 v[54:55], v[178:179], v[18:19], v[54:55] op_sel:[0,0,0] op_sel_hi:[1,0,1] neg_lo:[1,0,0] neg_hi:[1,0,0]
    v_pk_fma_f32 v[52:53], v[52:53], v[18:19], v[204:205] op_sel:[0,1,0] op_sel_hi:[1,1,1]
    v_pk_fma_f32 v[54:55], v[54:55], v[18:19], v[206:207] op_sel:[0,1,0] op_sel_hi:[1,1,1]
    v_exp_f32 v128, -v52
    v_exp_f32 v129, -v53
    v_exp_f32 v130, -v54
    v_exp_f32 v131, -v55
    v_pk_fma_f32 v[128:129], v[128:129], s[34:35], s[34:35]
    v_pk_fma_f32 v[130:131], v[130:131], s[34:35], s[34:35]
    v_rcp_f32 v128, v128
    v_rcp_f32 v129, v129
    v_rcp_f32 v130, v130
    v_rcp_f32 v131, v131
    v_pk_mul_f32 v[52:53], v[52:53], v[128:129]
    v_pk_mul_f32 v[54:55], v[54:55], v[130:131]
    v_cvt_pk_bf16_f32 v98, v52, v53
    v_cvt_pk_bf16_f32 v99, v54, v55
    global_store_dwordx4 v9, v[96:99], s[4:5] offset:1024 sc1
    v_add_u32 v9, 4096, v9
    v_pk_fma_f32 v[28:29], v[180:181], v[16:17], v[28:29] op_sel:[0,0,0] op_sel_hi:[1,0,1] neg_lo:[1,0,0] neg_hi:[1,0,0]
    v_pk_fma_f32 v[30:31], v[182:183], v[16:17], v[30:31] op_sel:[0,0,0] op_sel_hi:[1,0,1] neg_lo:[1,0,0] neg_hi:[1,0,0]
    v_pk_fma_f32 v[28:29], v[28:29], v[16:17], v[208:209] op_sel:[0,1,0] op_sel_hi:[1,1,1]
    v_pk_fma_f32 v[30:31], v[30:31], v[16:17], v[210:211] op_sel:[0,1,0] op_sel_hi:[1,1,1]
    v_exp_f32 v124, -v28
    v_exp_f32 v125, -v29
    v_exp_f32 v126, -v30
    v_exp_f32 v127, -v31
    v_pk_fma_f32 v[124:125], v[124:125], s[34:35], s[34:35]
    v_pk_fma_f32 v[126:127], v[126:127], s[34:35], s[34:35]
    v_rcp_f32 v124, v124
    v_rcp_f32 v125, v125
    v_rcp_f32 v126, v126
    v_rcp_f32 v127, v127
    v_pk_mul_f32 v[28:29], v[28:29], v[124:125]
    v_pk_mul_f32 v[30:31], v[30:31], v[126:127]
    v_cvt_pk_bf16_f32 v100, v28, v29
    v_cvt_pk_bf16_f32 v101, v30, v31
    v_pk_fma_f32 v[32:33], v[184:185], v[16:17], v[32:33] op_sel:[0,0,0] op_sel_hi:[1,0,1] neg_lo:[1,0,0] neg_hi:[1,0,0]
    v_pk_fma_f32 v[34:35], v[186:187], v[16:17], v[34:35] op_sel:[0,0,0] op_sel_hi:[1,0,1] neg_lo:[1,0,0] neg_hi:[1,0,0]
    v_pk_fma_f32 v[32:33], v[32:33], v[16:17], v[212:213] op_sel:[0,1,0] op_sel_hi:[1,1,1]
    v_pk_fma_f32 v[34:35], v[34:35], v[16:17], v[214:215] op_sel:[0,1,0] op_sel_hi:[1,1,1]
    v_exp_f32 v128, -v32
    v_exp_f32 v129, -v33
    v_exp_f32 v130, -v34
    v_exp_f32 v131, -v35
    v_pk_fma_f32 v[128:129], v[128:129], s[34:35], s[34:35]
    v_pk_fma_f32 v[130:131], v[130:131], s[34:35], s[34:35]
    v_rcp_f32 v128, v128
    v_rcp_f32 v129, v129
    v_rcp_f32 v130, v130
    v_rcp_f32 v131, v131
    v_pk_mul_f32 v[32:33], v[32:33], v[128:129]
    v_pk_mul_f32 v[34:35], v[34:35], v[130:131]
    v_cvt_pk_bf16_f32 v102, v32, v33
    v_cvt_pk_bf16_f32 v103, v34, v35
    global_store_dwordx4 v9, v[100:103], s[4:5] offset:0 sc1
    v_pk_fma_f32 v[56:57], v[180:181], v[18:19], v[56:57] op_sel:[0,0,0] op_sel_hi:[1,0,1] neg_lo:[1,0,0] neg_hi:[1,0,0]
    v_pk_fma_f32 v[58:59], v[182:183], v[18:19], v[58:59] op_sel:[0,0,0] op_sel_hi:[1,0,1] neg_lo:[1,0,0] neg_hi:[1,0,0]
    v_pk_fma_f32 v[56:57], v[56:57], v[18:19], v[208:209] op_sel:[0,1,0] op_sel_hi:[1,1,1]
    v_pk_fma_f32 v[58:59], v[58:59], v[18:19], v[210:211] op_sel:[0,1,0] op_sel_hi:[1,1,1]
    v_exp_f32 v124, -v56
    v_exp_f32 v125, -v57
    v_exp_f32 v126, -v58
    v_exp_f32 v127, -v59
    v_pk_fma_f32 v[124:125], v[124:125], s[34:35], s[34:35]
    v_pk_fma_f32 v[126:127], v[126:127], s[34:35], s[34:35]
    v_rcp_f32 v124, v124
    v_rcp_f32 v125, v125
    v_rcp_f32 v126, v126
    v_rcp_f32 v127, v127
    v_pk_mul_f32 v[56:57], v[56:57], v[124:125]
    v_pk_mul_f32 v[58:59], v[58:59], v[126:127]
    v_cvt_pk_bf16_f32 v104, v56, v57
    v_cvt_pk_bf16_f32 v105, v58, v59
    v_pk_fma_f32 v[60:61], v[184:185], v[18:19], v[60:61] op_sel:[0,0,0] op_sel_hi:[1,0,1] neg_lo:[1,0,0] neg_hi:[1,0,0]
    v_pk_fma_f32 v[62:63], v[186:187], v[18:19], v[62:63] op_sel:[0,0,0] op_sel_hi:[1,0,1] neg_lo:[1,0,0] neg_hi:[1,0,0]
    v_pk_fma_f32 v[60:61], v[60:61], v[18:19], v[212:213] op_sel:[0,1,0] op_sel_hi:[1,1,1]
    v_pk_fma_f32 v[62:63], v[62:63], v[18:19], v[214:215] op_sel:[0,1,0] op_sel_hi:[1,1,1]
    v_exp_f32 v128, -v60
    v_exp_f32 v129, -v61
    v_exp_f32 v130, -v62
    v_exp_f32 v131, -v63
    v_pk_fma_f32 v[128:129], v[128:129], s[34:35], s[34:35]
    v_pk_fma_f32 v[130:131], v[130:131], s[34:35], s[34:35]
    v_rcp_f32 v128, v128
    v_rcp_f32 v129, v129
    v_rcp_f32 v130, v130
    v_rcp_f32 v131, v131
    v_pk_mul_f32 v[60:61], v[60:61], v[128:129]
    v_pk_mul_f32 v[62:63], v[62:63], v[130:131]
    v_cvt_pk_bf16_f32 v106, v60, v61
    v_cvt_pk_bf16_f32 v107, v62, v63
    global_store_dwordx4 v9, v[104:107], s[4:5] offset:1024 sc1
    v_add_u32 v9, 4096, v9
    v_pk_fma_f32 v[36:37], v[188:189], v[16:17], v[36:37] op_sel:[0,0,0] op_sel_hi:[1,0,1] neg_lo:[1,0,0] neg_hi:[1,0,0]
    v_pk_fma_f32 v[38:39], v[190:191], v[16:17], v[38:39] op_sel:[0,0,0] op_sel_hi:[1,0,1] neg_lo:[1,0,0] neg_hi:[1,0,0]
    v_pk_fma_f32 v[36:37], v[36:37], v[16:17], v[216:217] op_sel:[0,1,0] op_sel_hi:[1,1,1]
    v_pk_fma_f32 v[38:39], v[38:39], v[16:17], v[218:219] op_sel:[0,1,0] op_sel_hi:[1,1,1]
    v_exp_f32 v124, -v36
    v_exp_f32 v125, -v37
    v_exp_f32 v126, -v38
    v_exp_f32 v127, -v39
    v_pk_fma_f32 v[124:125], v[124:125], s[34:35], s[34:35]
    v_pk_fma_f32 v[126:127], v[126:127], s[34:35], s[34:35]
    v_rcp_f32 v124, v124
    v_rcp_f32 v125, v125
    v_rcp_f32 v126, v126
    v_rcp_f32 v127, v127
    v_pk_mul_f32 v[36:37], v[36:37], v[124:125]
    v_pk_mul_f32 v[38:39], v[38:39], v[126:127]
    v_cvt_pk_bf16_f32 v108, v36, v37
    v_cvt_pk_bf16_f32 v109, v38, v39
    v_pk_fma_f32 v[40:41], v[192:193], v[16:17], v[40:41] op_sel:[0,0,0] op_sel_hi:[1,0,1] neg_lo:[1,0,0] neg_hi:[1,0,0]
    v_pk_fma_f32 v[42:43], v[194:195], v[16:17], v[42:43] op_sel:[0,0,0] op_sel_hi:[1,0,1] neg_lo:[1,0,0] neg_hi:[1,0,0]
    v_pk_fma_f32 v[40:41], v[40:41], v[16:17], v[220:221] op_sel:[0,1,0] op_sel_hi:[1,1,1]
    v_pk_fma_f32 v[42:43], v[42:43], v[16:17], v[222:223] op_sel:[0,1,0] op_sel_hi:[1,1,1]
    v_exp_f32 v128, -v40
    v_exp_f32 v129, -v41
    v_exp_f32 v130, -v42
    v_exp_f32 v131, -v43
    v_pk_fma_f32 v[128:129], v[128:129], s[34:35], s[34:35]
    v_pk_fma_f32 v[130:131], v[130:131], s[34:35], s[34:35]
    v_rcp_f32 v128, v128
    v_rcp_f32 v129, v129
    v_rcp_f32 v130, v130
    v_rcp_f32 v131, v131
    v_pk_mul_f32 v[40:41], v[40:41], v[128:129]
    v_pk_mul_f32 v[42:43], v[42:43], v[130:131]
    v_cvt_pk_bf16_f32 v110, v40, v41
    v_cvt_pk_bf16_f32 v111, v42, v43
    global_store_dwordx4 v9, v[108:111], s[4:5] offset:0 sc1
    v_pk_fma_f32 v[64:65], v[188:189], v[18:19], v[64:65] op_sel:[0,0,0] op_sel_hi:[1,0,1] neg_lo:[1,0,0] neg_hi:[1,0,0]
    v_pk_fma_f32 v[66:67], v[190:191], v[18:19], v[66:67] op_sel:[0,0,0] op_sel_hi:[1,0,1] neg_lo:[1,0,0] neg_hi:[1,0,0]
    v_pk_fma_f32 v[64:65], v[64:65], v[18:19], v[216:217] op_sel:[0,1,0] op_sel_hi:[1,1,1]
    v_pk_fma_f32 v[66:67], v[66:67], v[18:19], v[218:219] op_sel:[0,1,0] op_sel_hi:[1,1,1]
    v_exp_f32 v124, -v64
    v_exp_f32 v125, -v65
    v_exp_f32 v126, -v66
    v_exp_f32 v127, -v67
    v_pk_fma_f32 v[124:125], v[124:125], s[34:35], s[34:35]
    v_pk_fma_f32 v[126:127], v[126:127], s[34:35], s[34:35]
    v_rcp_f32 v124, v124
    v_rcp_f32 v125, v125
    v_rcp_f32 v126, v126
    v_rcp_f32 v127, v127
    v_pk_mul_f32 v[64:65], v[64:65], v[124:125]
    v_pk_mul_f32 v[66:67], v[66:67], v[126:127]
    v_cvt_pk_bf16_f32 v112, v64, v65
    v_cvt_pk_bf16_f32 v113, v66, v67
    v_pk_fma_f32 v[68:69], v[192:193], v[18:19], v[68:69] op_sel:[0,0,0] op_sel_hi:[1,0,1] neg_lo:[1,0,0] neg_hi:[1,0,0]
    v_pk_fma_f32 v[70:71], v[194:195], v[18:19], v[70:71] op_sel:[0,0,0] op_sel_hi:[1,0,1] neg_lo:[1,0,0] neg_hi:[1,0,0]
    v_pk_fma_f32 v[68:69], v[68:69], v[18:19], v[220:221] op_sel:[0,1,0] op_sel_hi:[1,1,1]
    v_pk_fma_f32 v[70:71], v[70:71], v[18:19], v[222:223] op_sel:[0,1,0] op_sel_hi:[1,1,1]
    v_exp_f32 v128, -v68
    v_exp_f32 v129, -v69
    v_exp_f32 v130, -v70
    v_exp_f32 v131, -v71
    v_pk_fma_f32 v[128:129], v[128:129], s[34:35], s[34:35]
    v_pk_fma_f32 v[130:131], v[130:131], s[34:35], s[34:35]
    v_rcp_f32 v128, v128
    v_rcp_f32 v129, v129
    v_rcp_f32 v130, v130
    v_rcp_f32 v131, v131
    v_pk_mul_f32 v[68:69], v[68:69], v[128:129]
    v_pk_mul_f32 v[70:71], v[70:71], v[130:131]
    v_cvt_pk_bf16_f32 v114, v68, v69
    v_cvt_pk_bf16_f32 v115, v70, v71
    global_store_dwordx4 v9, v[112:115], s[4:5] offset:1024 sc1
    v_pk_fma_f32 v[44:45], v[196:197], v[16:17], v[44:45] op_sel:[0,0,0] op_sel_hi:[1,0,1] neg_lo:[1,0,0] neg_hi:[1,0,0]
    v_pk_fma_f32 v[46:47], v[198:199], v[16:17], v[46:47] op_sel:[0,0,0] op_sel_hi:[1,0,1] neg_lo:[1,0,0] neg_hi:[1,0,0]
    v_pk_fma_f32 v[44:45], v[44:45], v[16:17], v[224:225] op_sel:[0,1,0] op_sel_hi:[1,1,1]
    v_pk_fma_f32 v[46:47], v[46:47], v[16:17], v[226:227] op_sel:[0,1,0] op_sel_hi:[1,1,1]
    v_exp_f32 v124, -v44
    v_exp_f32 v125, -v45
    v_exp_f32 v126, -v46
    v_exp_f32 v127, -v47
    v_pk_fma_f32 v[124:125], v[124:125], s[34:35], s[34:35]
    v_pk_fma_f32 v[126:127], v[126:127], s[34:35], s[34:35]
    v_rcp_f32 v124, v124
    v_rcp_f32 v125, v125
    v_rcp_f32 v126, v126
    v_rcp_f32 v127, v127
    v_pk_mul_f32 v[44:45], v[44:45], v[124:125]
    v_pk_mul_f32 v[46:47], v[46:47], v[126:127]
    v_cvt_pk_bf16_f32 v116, v44, v45
    v_cvt_pk_bf16_f32 v117, v46, v47
    global_store_dwordx2 v10, v[116:117], s[4:5] offset:0 sc1
    v_pk_fma_f32 v[72:73], v[196:197], v[18:19], v[72:73] op_sel:[0,0,0] op_sel_hi:[1,0,1] neg_lo:[1,0,0] neg_hi:[1,0,0]
    v_pk_fma_f32 v[74:75], v[198:199], v[18:19], v[74:75] op_sel:[0,0,0] op_sel_hi:[1,0,1] neg_lo:[1,0,0] neg_hi:[1,0,0]
    v_pk_fma_f32 v[72:73], v[72:73], v[18:19], v[224:225] op_sel:[0,1,0] op_sel_hi:[1,1,1]
    v_pk_fma_f32 v[74:75], v[74:75], v[18:19], v[226:227] op_sel:[0,1,0] op_sel_hi:[1,1,1]
    v_exp_f32 v128, -v72
    v_exp_f32 v129, -v73
    v_exp_f32 v130, -v74
    v_exp_f32 v131, -v75
    v_pk_fma_f32 v[128:129], v[128:129], s[34:35], s[34:35]
    v_pk_fma_f32 v[130:131], v[130:131], s[34:35], s[34:35]
    v_rcp_f32 v128, v128
    v_rcp_f32 v129, v129
    v_rcp_f32 v130, v130
    v_rcp_f32 v131, v131
    v_pk_mul_f32 v[72:73], v[72:73], v[128:129]
    v_pk_mul_f32 v[74:75], v[74:75], v[130:131]
    v_cvt_pk_bf16_f32 v120, v72, v73
    v_cvt_pk_bf16_f32 v121, v74, v75
    global_store_dwordx2 v10, v[120:121], s[4:5] offset:1024 sc1
    s_lshl_b32 s15, s9, 1
    s_add_u32 s15, s15, s3
    s_mul_i32 s14, s15, 229376
    s_add_u32 s14, s14, 0x1000000
    s_add_u32 s14, s14, s56
    s_add_u32 s26, s4, s14
    s_addc_u32 s27, s5, 0
    v_lshlrev_b32 v17, 3, v2
    s_add_u32 s14, s10, 0
    s_and_b32 s14, s14, 3
    s_lshl_b32 s14, s14, 10
    v_add_u32 v8, s14, v5
    v_add_u32 v12, s14, v17
    s_mul_i32 s14, s14, 12
    v_add_u32 v84, s14, v5
    s_add_u32 s14, s10, 1
    s_and_b32 s14, s14, 3
    s_lshl_b32 s14, s14, 10
    v_add_u32 v9, s14, v5
    v_add_u32 v13, s14, v17
    s_mul_i32 s14, s14, 12
    v_add_u32 v85, s14, v5
    s_add_u32 s14, s10, 2
    s_and_b32 s14, s14, 3
    s_lshl_b32 s14, s14, 10
    v_add_u32 v10, s14, v5
    v_add_u32 v14, s14, v17
    s_mul_i32 s14, s14, 12
    v_add_u32 v86, s14, v5
    s_add_u32 s14, s10, 3
    s_and_b32 s14, s14, 3
    s_lshl_b32 s14, s14, 10
    v_add_u32 v11, s14, v5
    v_add_u32 v15, s14, v17
    s_mul_i32 s14, s14, 12
    v_add_u32 v87, s14, v5
    s_lshl_b32 s14, s15, 6
    s_lshl_b32 s15, s10, 4
    s_add_u32 s14, s14, s15
    v_add_u32 v16, s14, v3
    v_lshlrev_b32 v16, 10, v16
    v_lshl_add_u32 v16, v4, 4, v16
    s_lshl_b32 s14, s17, 7
    v_add_u32 v16, s14, v16
    v_lshlrev_b32 v172, 16, v228
    v_and_b32 v176, 0xffff0000, v228
    v_lshlrev_b32 v173, 16, v229
    v_and_b32 v177, 0xffff0000, v229
    v_lshlrev_b32 v174, 16, v230
    v_and_b32 v178, 0xffff0000, v230
    v_lshlrev_b32 v175, 16, v231
    v_and_b32 v179, 0xffff0000, v231
    v_lshlrev_b32 v180, 16, v232
    v_and_b32 v184, 0xffff0000, v232
    v_lshlrev_b32 v181, 16, v233
    v_and_b32 v185, 0xffff0000, v233
    v_lshlrev_b32 v182, 16, v234
    v_and_b32 v186, 0xffff0000, v234
    v_lshlrev_b32 v183, 16, v235
    v_and_b32 v187, 0xffff0000, v235
    s_waitcnt vmcnt(0)
    s_barrier
    s_cmp_lg_u32 s10, 0
    s_cbranch_scc1 g_sig_46
    s_mov_b64 exec, 1
    global_atomic_add v253, v254, s[4:5] offset:128 sc1
    s_mov_b64 exec, -1
g_sig_46:
    global_load_dwordx4 a[152:155], v252, s[52:53] offset:2048 sc1
    global_load_dwordx4 a[156:159], v252, s[52:53] offset:3072 sc1
    s_add_u32 s52, s52, 4096
    s_addc_u32 s53, s53, 0
    global_load_dwordx4 a[160:163], v252, s[52:53] offset:0 sc1
    global_load_dwordx4 a[164:167], v252, s[52:53] offset:1024 sc1
    global_load_dwordx4 a[168:171], v252, s[52:53] offset:2048 sc1
    global_load_dwordx4 a[172:175], v252, s[52:53] offset:3072 sc1
    s_add_u32 s52, s52, 4096
    s_addc_u32 s53, s53, 0
    global_load_dwordx4 a[176:179], v252, s[52:53] offset:0 sc1
    global_load_dwordx4 a[180:183], v252, s[52:53] offset:1024 sc1
    global_load_dwordx4 a[184:187], v252, s[52:53] offset:2048 sc1
    global_load_dwordx4 a[188:191], v252, s[52:53] offset:3072 sc1
    s_add_u32 s52, s52, 4096
    s_addc_u32 s53, s53, 0
    global_load_dwordx4 a[192:195], v252, s[52:53] offset:0 sc1
    global_load_dwordx4 a[196:199], v252, s[52:53] offset:1024 sc1
    global_load_dwordx4 a[200:203], v252, s[52:53] offset:2048 sc1
    global_load_dwordx4 a[204:207], v252, s[52:53] offset:3072 sc1
    s_add_u32 s52, s52, 4096
    s_addc_u32 s53, s53, 0
    global_load_dwordx4 a[208:211], v252, s[52:53] offset:0 sc1
    global_load_dwordx4 a[212:215], v252, s[52:53] offset:1024 sc1
    global_load_dwordx4 a[216:219], v252, s[52:53] offset:2048 sc1
    global_load_dwordx4 a[220:223], v252, s[52:53] offset:3072 sc1
    s_cmp_lg_u32 s10, 1
    s_cbranch_scc1 g2_np_47
    s_mov_b32 s14, 200000
    global_load_dword v171, v253, s[4:5] offset:128 sc1
pp_l_49:
    s_waitcnt vmcnt(0)
    v_cmp_gt_u32 vcc, 16, v171
    s_nop 1
    s_cmp_eq_u64 vcc, 0
    s_cbranch_scc1 pp_go_48
    s_sleep 1
    global_load_dword v171, v253, s[4:5] offset:128 sc1
    s_sub_u32 s14, s14, 1
    s_cmp_lg_u32 s14, 0
    s_cbranch_scc1 pp_l_49
pp_go_48:
g2_np_47:
    s_barrier
    s_add_u32 s14, s54, 0
    s_add_u32 s28, s26, s14
    s_addc_u32 s29, s27, 0
    global_load_dwordx4 v[136:139], v9, s[28:29] sc1
    global_load_dwordx4 v[140:143], v10, s[28:29] sc1
    global_load_dwordx4 v[144:147], v11, s[28:29] sc1
    global_load_dwordx4 v[132:135], v8, s[28:29] sc1
    s_add_u32 s14, s54, 4096
    s_add_u32 s28, s26, s14
    s_addc_u32 s29, s27, 0
    global_load_dwordx4 v[152:155], v9, s[28:29] sc1
    global_load_dwordx4 v[156:159], v10, s[28:29] sc1
    global_load_dwordx4 v[160:163], v11, s[28:29] sc1
    global_load_dwordx4 v[148:151], v8, s[28:29] sc1
    s_add_u32 s14, s54, 8192
    s_add_u32 s28, s26, s14
    s_addc_u32 s29, s27, 0
    global_load_dwordx4 v[96:99], v9, s[28:29] sc1
    global_load_dwordx4 v[100:103], v10, s[28:29] sc1
    global_load_dwordx4 v[104:107], v11, s[28:29] sc1
    global_load_dwordx4 v[92:95], v8, s[28:29] sc1
    s_waitcnt vmcnt(11)
    v_mfma_f32_16x16x32_bf16 v[24:27], a[0:3], v[136:139], 0
    s_add_u32 s14, s54, 12288
    s_add_u32 s28, s26, s14
    s_addc_u32 s29, s27, 0
    v_mfma_f32_16x16x32_bf16 v[40:43], a[4:7], v[136:139], 0
    v_mfma_f32_16x16x32_bf16 v[56:59], a[8:11], v[136:139], 0
    v_mfma_f32_16x16x32_bf16 v[72:75], a[12:15], v[136:139], 0
    global_load_dwordx4 v[112:115], v9, s[28:29] sc1
    s_waitcnt vmcnt(11)
    v_mfma_f32_16x16x32_bf16 v[28:31], a[0:3], v[140:143], 0
    v_mfma_f32_16x16x32_bf16 v[44:47], a[4:7], v[140:143], 0
    v_mfma_f32_16x16x32_bf16 v[60:63], a[8:11], v[140:143], 0
    v_mfma_f32_16x16x32_bf16 v[76:79], a[12:15], v[140:143], 0
    global_load_dwordx4 v[116:119], v10, s[28:29] sc1
    s_waitcnt vmcnt(11)
    v_mfma_f32_16x16x32_bf16 v[32:35], a[0:3], v[144:147], 0
    v_mfma_f32_16x16x32_bf16 v[48:51], a[4:7], v[144:147], 0
    v_mfma_f32_16x16x32_bf16 v[64:67], a[8:11], v[144:147], 0
    v_mfma_f32_16x16x32_bf16 v[80:83], a[12:15], v[144:147], 0
    global_load_dwordx4 v[120:123], v11, s[28:29] sc1
    s_waitcnt vmcnt(11)
    v_mfma_f32_16x16x32_bf16 v[20:23], a[0:3], v[132:135], 0
    v_mfma_f32_16x16x32_bf16 v[36:39], a[4:7], v[132:135], 0
    v_mfma_f32_16x16x32_bf16 v[52:55], a[8:11], v[132:135], 0
    v_mfma_f32_16x16x32_bf16 v[68:71], a[12:15], v[132:135], 0
    global_load_dwordx4 v[108:111], v8, s[28:29] sc1
    s_waitcnt vmcnt(11)
    v_mfma_f32_16x16x32_bf16 v[24:27], a[16:19], v[152:155], v[24:27]
    s_add_u32 s14, s54, 16384
    s_add_u32 s28, s26, s14
    s_addc_u32 s29, s27, 0
    v_mfma_f32_16x16x32_bf16 v[40:43], a[20:23], v[152:155], v[40:43]
    v_mfma_f32_16x16x32_bf16 v[56:59], a[24:27], v[152:155], v[56:59]
    v_mfma_f32_16x16x32_bf16 v[72:75], a[28:31], v[152:155], v[72:75]
    global_load_dwordx4 v[136:139], v9, s[28:29] sc1
    s_waitcnt vmcnt(11)
    v_mfma_f32_16x16x32_bf16 v[28:31], a[16:19], v[156:159], v[28:31]
    v_mfma_f32_16x16x32_bf16 v[44:47], a[20:23], v[156:159], v[44:47]
    v_mfma_f32_16x16x32_bf16 v[60:63], a[24:27], v[156:159], v[60:63]
    v_mfma_f32_16x16x32_bf16 v[76:79], a[28:31], v[156:159], v[76:79]
    global_load_dwordx4 v[140:143], v10, s[28:29] sc1
    s_waitcnt vmcnt(11)
    v_mfma_f32_16x16x32_bf16 v[32:35], a[16:19], v[160:163], v[32:35]
    v_mfma_f32_16x16x32_bf16 v[48:51], a[20:23], v[160:163], v[48:51]
    v_mfma_f32_16x16x32_bf16 v[64:67], a[24:27], v[160:163], v[64:67]
    v_mfma_f32_16x16x32_bf16 v[80:83], a[28:31], v[160:163], v[80:83]
    global_load_dwordx4 v[144:147], v11, s[28:29] sc1
    s_waitcnt vmcnt(11)
    v_mfma_f32_16x16x32_bf16 v[20:23], a[16:19], v[148:151], v[20:23]
    v_mfma_f32_16x16x32_bf16 v[36:39], a[20:23], v[148:151], v[36:39]
    v_mfma_f32_16x16x32_bf16 v[52:55], a[24:27], v[148:151], v[52:55]
    v_mfma_f32_16x16x32_bf16 v[68:71], a[28:31], v[148:151], v[68:71]
    global_load_dwordx4 v[132:135], v8, s[28:29] sc1
    s_waitcnt vmcnt(11)
    v_mfma_f32_16x16x32_bf16 v[24:27], a[32:35], v[96:99], v[24:27]
    s_add_u32 s14, s54, 20480
    s_add_u32 s28, s26, s14
    s_addc_u32 s29, s27, 0
    v_mfma_f32_16x16x32_bf16 v[40:43], a[36:39], v[96:99], v[40:43]
    v_mfma_f32_16x16x32_bf16 v[56:59], a[40:43], v[96:99], v[56:59]
    v_mfma_f32_16x16x32_bf16 v[72:75], a[44:47], v[96:99], v[72:75]
    global_load_dwordx4 v[152:155], v9, s[28:29] sc1
    s_waitcnt vmcnt(11)
    v_mfma_f32_16x16x32_bf16 v[28:31], a[32:35], v[100:103], v[28:31]
    v_mfma_f32_16x16x32_bf16 v[44:47], a[36:39], v[100:103], v[44:47]
    v_mfma_f32_16x16x32_bf16 v[60:63], a[40:43], v[100:103], v[60:63]
    v_mfma_f32_16x16x32_bf16 v[76:79], a[44:47], v[100:103], v[76:79]
    global_load_dwordx4 v[156:159], v10, s[28:29] sc1
    s_waitcnt vmcnt(11)
    v_mfma_f32_16x16x32_bf16 v[32:35], a[32:35], v[104:107], v[32:35]
    v_mfma_f32_16x16x32_bf16 v[48:51], a[36:39], v[104:107], v[48:51]
    v_mfma_f32_16x16x32_bf16 v[64:67], a[40:43], v[104:107], v[64:67]
    v_mfma_f32_16x16x32_bf16 v[80:83], a[44:47], v[104:107], v[80:83]
    global_load_dwordx4 v[160:163], v11, s[28:29] sc1
    s_waitcnt vmcnt(11)
    v_mfma_f32_16x16x32_bf16 v[20:23], a[32:35], v[92:95], v[20:23]
    v_mfma_f32_16x16x32_bf16 v[36:39], a[36:39], v[92:95], v[36:39]
    v_mfma_f32_16x16x32_bf16 v[52:55], a[40:43], v[92:95], v[52:55]
    v_mfma_f32_16x16x32_bf16 v[68:71], a[44:47], v[92:95], v[68:71]
    global_load_dwordx4 v[148:151], v8, s[28:29] sc1
    s_waitcnt vmcnt(11)
    v_mfma_f32_16x16x32_bf16 v[24:27], a[48:51], v[112:115], v[24:27]
    s_add_u32 s14, s54, 24576
    s_add_u32 s28, s26, s14
    s_addc_u32 s29, s27, 0
    v_mfma_f32_16x16x32_bf16 v[40:43], a[52:55], v[112:115], v[40:43]
    v_mfma_f32_16x16x32_bf16 v[56:59], a[56:59], v[112:115], v[56:59]
    v_mfma_f32_16x16x32_bf16 v[72:75], a[60:63], v[112:115], v[72:75]
    global_load_dwordx2 v[96:97], v13, s[28:29] sc1
    global_load_dwordx2 v[98:99], v13, s[28:29] offset:512 sc1
    s_waitcnt vmcnt(12)
    v_mfma_f32_16x16x32_bf16 v[28:31], a[48:51], v[116:119], v[28:31]
    v_mfma_f32_16x16x32_bf16 v[44:47], a[52:55], v[116:119], v[44:47]
    v_mfma_f32_16x16x32_bf16 v[60:63], a[56:59], v[116:119], v[60:63]
    v_mfma_f32_16x16x32_bf16 v[76:79], a[60:63], v[116:119], v[76:79]
    global_load_dwordx2 v[100:101], v14, s[28:29] sc1
    global_load_dwordx2 v[102:103], v14, s[28:29] offset:512 sc1
    s_waitcnt vmcnt(13)
    v_mfma_f32_16x16x32_bf16 v[32:35], a[48:51], v[120:123], v[32:35]
    v_mfma_f32_16x16x32_bf16 v[48:51], a[52:55], v[120:123], v[48:51]
    v_mfma_f32_16x16x32_bf16 v[64:67], a[56:59], v[120:123], v[64:67]
    v_mfma_f32_16x16x32_bf16 v[80:83], a[60:63], v[120:123], v[80:83]
    global_load_dwordx2 v[104:105], v15, s[28:29] sc1
    global_load_dwordx2 v[106:107], v15, s[28:29] offset:512 sc1
    s_waitcnt vmcnt(14)
    v_mfma_f32_16x16x32_bf16 v[20:23], a[48:51], v[108:111], v[20:23]
    v_mfma_f32_16x16x32_bf16 v[36:39], a[52:55], v[108:111], v[36:39]
    v_mfma_f32_16x16x32_bf16 v[52:55], a[56:59], v[108:111], v[52:55]
    v_mfma_f32_16x16x32_bf16 v[68:71], a[60:63], v[108:111], v[68:71]
    global_load_dwordx2 v[92:93], v12, s[28:29] sc1
    global_load_dwordx2 v[94:95], v12, s[28:29] offset:512 sc1
    s_waitcnt vmcnt(15)
    v_mfma_f32_16x16x32_bf16 v[24:27], a[64:67], v[136:139], v[24:27]
    s_add_u32 s14, s55, 0
    s_add_u32 s28, s26, s14
    s_addc_u32 s29, s27, 0
    v_mfma_f32_16x16x32_bf16 v[40:43], a[68:71], v[136:139], v[40:43]
    v_mfma_f32_16x16x32_bf16 v[56:59], a[72:75], v[136:139], v[56:59]
    v_mfma_f32_16x16x32_bf16 v[72:75], a[76:79], v[136:139], v[72:75]
    global_load_dwordx4 v[112:115], v9, s[28:29] sc1
    s_waitcnt vmcnt(15)
    v_mfma_f32_16x16x32_bf16 v[28:31], a[64:67], v[140:143], v[28:31]
    v_mfma_f32_16x16x32_bf16 v[44:47], a[68:71], v[140:143], v[44:47]
    v_mfma_f32_16x16x32_bf16 v[60:63], a[72:75], v[140:143], v[60:63]
    v_mfma_f32_16x16x32_bf16 v[76:79], a[76:79], v[140:143], v[76:79]
    global_load_dwordx4 v[116:119], v10, s[28:29] sc1
    s_waitcnt vmcnt(15)
    v_mfma_f32_16x16x32_bf16 v[32:35], a[64:67], v[144:147], v[32:35]
    v_mfma_f32_16x16x32_bf16 v[48:51], a[68:71], v[144:147], v[48:51]
    v_mfma_f32_16x16x32_bf16 v[64:67], a[72:75], v[144:147], v[64:67]
    v_mfma_f32_16x16x32_bf16 v[80:83], a[76:79], v[144:147], v[80:83]
    global_load_dwordx4 v[120:123], v11, s[28:29] sc1
    s_waitcnt vmcnt(15)
    v_mfma_f32_16x16x32_bf16 v[20:23], a[64:67], v[132:135], v[20:23]
    v_mfma_f32_16x16x32_bf16 v[36:39], a[68:71], v[132:135], v[36:39]
    v_mfma_f32_16x16x32_bf16 v[52:55], a[72:75], v[132:135], v[52:55]
    v_mfma_f32_16x16x32_bf16 v[68:71], a[76:79], v[132:135], v[68:71]
    global_load_dwordx4 v[108:111], v8, s[28:29] sc1
    s_waitcnt vmcnt(15)
    v_mfma_f32_16x16x32_bf16 v[24:27], a[80:83], v[152:155], v[24:27]
    s_add_u32 s14, s55, 4096
    s_add_u32 s28, s26, s14
    s_addc_u32 s29, s27, 0
    v_mfma_f32_16x16x32_bf16 v[40:43], a[84:87], v[152:155], v[40:43]
    v_mfma_f32_16x16x32_bf16 v[56:59], a[88:91], v[152:155], v[56:59]
    v_mfma_f32_16x16x32_bf16 v[72:75], a[92:95], v[152:155], v[72:75]
    global_load_dwordx4 v[136:139], v9, s[28:29] sc1
    s_waitcnt vmcnt(15)
    v_mfma_f32_16x16x32_bf16 v[28:31], a[80:83], v[156:159], v[28:31]
    v_mfma_f32_16x16x32_bf16 v[44:47], a[84:87], v[156:159], v[44:47]
    v_mfma_f32_16x16x32_bf16 v[60:63], a[88:91], v[156:159], v[60:63]
    v_mfma_f32_16x16x32_bf16 v[76:79], a[92:95], v[156:159], v[76:79]
    global_load_dwordx4 v[140:143], v10, s[28:29] sc1
    s_waitcnt vmcnt(15)
    v_mfma_f32_16x16x32_bf16 v[32:35], a[80:83], v[160:163], v[32:35]
    v_mfma_f32_16x16x32_bf16 v[48:51], a[84:87], v[160:163], v[48:51]
    v_mfma_f32_16x16x32_bf16 v[64:67], a[88:91], v[160:163], v[64:67]
    v_mfma_f32_16x16x32_bf16 v[80:83], a[92:95], v[160:163], v[80:83]
    global_load_dwordx4 v[144:147], v11, s[28:29] sc1
    s_waitcnt vmcnt(15)
    v_mfma_f32_16x16x32_bf16 v[20:23], a[80:83], v[148:151], v[20:23]
    v_mfma_f32_16x16x32_bf16 v[36:39], a[84:87], v[148:151], v[36:39]
    v_mfma_f32_16x16x32_bf16 v[52:55], a[88:91], v[148:151], v[52:55]
    v_mfma_f32_16x16x32_bf16 v[68:71], a[92:95], v[148:151], v[68:71]
    global_load_dwordx4 v[132:135], v8, s[28:29] sc1
    s_waitcnt vmcnt(14)
    v_mfma_f32_16x16x32_bf16 v[24:27], a[96:99], v[96:99], v[24:27]
    s_add_u32 s14, s55, 8192
    s_add_u32 s28, s26, s14
    s_addc_u32 s29, s27, 0
    v_mfma_f32_16x16x32_bf16 v[40:43], a[100:103], v[96:99], v[40:43]
    v_mfma_f32_16x16x32_bf16 v[56:59], a[104:107], v[96:99], v[56:59]
    v_mfma_f32_16x16x32_bf16 v[72:75], a[108:111], v[96:99], v[72:75]
    global_load_dwordx4 v[152:155], v9, s[28:29] sc1
    s_waitcnt vmcnt(13)
    v_mfma_f32_16x16x32_bf16 v[28:31], a[96:99], v[100:103], v[28:31]
    v_mfma_f32_16x16x32_bf16 v[44:47], a[100:103], v[100:103], v[44:47]
    v_mfma_f32_16x16x32_bf16 v[60:63], a[104:107], v[100:103], v[60:63]
    v_mfma_f32_16x16x32_bf16 v[76:79], a[108:111], v[100:103], v[76:79]
    global_load_dwordx4 v[156:159], v10, s[28:29] sc1
    s_waitcnt vmcnt(12)
    v_mfma_f32_16x16x32_bf16 v[32:35], a[96:99], v[104:107], v[32:35]
    v_mfma_f32_16x16x32_bf16 v[48:51], a[100:103], v[104:107], v[48:51]
    v_mfma_f32_16x16x32_bf16 v[64:67], a[104:107], v[104:107], v[64:67]
    v_mfma_f32_16x16x32_bf16 v[80:83], a[108:111], v[104:107], v[80:83]
    global_load_dwordx4 v[160:163], v11, s[28:29] sc1
    s_waitcnt vmcnt(11)
    v_mfma_f32_16x16x32_bf16 v[20:23], a[96:99], v[92:95], v[20:23]
    v_mfma_f32_16x16x32_bf16 v[36:39], a[100:103], v[92:95], v[36:39]
    v_mfma_f32_16x16x32_bf16 v[52:55], a[104:107], v[92:95], v[52:55]
    v_mfma_f32_16x16x32_bf16 v[68:71], a[108:111], v[92:95], v[68:71]
    global_load_dwordx4 v[148:151], v8, s[28:29] sc1
    s_waitcnt vmcnt(11)
    v_mfma_f32_16x16x32_bf16 v[24:27], a[112:115], v[112:115], v[24:27]
    s_add_u32 s14, s55, 12288
    s_add_u32 s28, s26, s14
    s_addc_u32 s29, s27, 0
    v_mfma_f32_16x16x32_bf16 v[40:43], a[116:119], v[112:115], v[40:43]
    v_mfma_f32_16x16x32_bf16 v[56:59], a[120:123], v[112:115], v[56:59]
    v_mfma_f32_16x16x32_bf16 v[72:75], a[124:127], v[112:115], v[72:75]
    global_load_dwordx4 v[96:99], v9, s[28:29] sc1
    s_waitcnt vmcnt(11)
    v_mfma_f32_16x16x32_bf16 v[28:31], a[112:115], v[116:119], v[28:31]
    v_mfma_f32_16x16x32_bf16 v[44:47], a[116:119], v[116:119], v[44:47]
    v_mfma_f32_16x16x32_bf16 v[60:63], a[120:123], v[116:119], v[60:63]
    v_mfma_f32_16x16x32_bf16 v[76:79], a[124:127], v[116:119], v[76:79]
    global_load_dwordx4 v[100:103], v10, s[28:29] sc1
    s_waitcnt vmcnt(11)
    v_mfma_f32_16x16x32_bf16 v[32:35], a[112:115], v[120:123], v[32:35]
    v_mfma_f32_16x16x32_bf16 v[48:51], a[116:119], v[120:123], v[48:51]
    v_mfma_f32_16x16x32_bf16 v[64:67], a[120:123], v[120:123], v[64:67]
    v_mfma_f32_16x16x32_bf16 v[80:83], a[124:127], v[120:123], v[80:83]
    global_load_dwordx4 v[104:107], v11, s[28:29] sc1
    s_waitcnt vmcnt(11)
    v_mfma_f32_16x16x32_bf16 v[20:23], a[112:115], v[108:111], v[20:23]
    v_mfma_f32_16x16x32_bf16 v[36:39], a[116:119], v[108:111], v[36:39]
    v_mfma_f32_16x16x32_bf16 v[52:55], a[120:123], v[108:111], v[52:55]
    v_mfma_f32_16x16x32_bf16 v[68:71], a[124:127], v[108:111], v[68:71]
    global_load_dwordx4 v[92:95], v8, s[28:29] sc1
    s_waitcnt vmcnt(11)
    v_mfma_f32_16x16x32_bf16 v[24:27], a[128:131], v[136:139], v[24:27]
    s_add_u32 s14, s55, 16384
    s_add_u32 s28, s26, s14
    s_addc_u32 s29, s27, 0
    v_mfma_f32_16x16x32_bf16 v[40:43], a[132:135], v[136:139], v[40:43]
    v_mfma_f32_16x16x32_bf16 v[56:59], a[136:139], v[136:139], v[56:59]
    v_mfma_f32_16x16x32_bf16 v[72:75], a[140:143], v[136:139], v[72:75]
    global_load_dwordx4 v[112:115], v9, s[28:29] sc1
    s_waitcnt vmcnt(11)
    v_mfma_f32_16x16x32_bf16 v[28:31], a[128:131], v[140:143], v[28:31]
    v_mfma_f32_16x16x32_bf16 v[44:47], a[132:135], v[140:143], v[44:47]
    v_mfma_f32_16x16x32_bf16 v[60:63], a[136:139], v[140:143], v[60:63]
    v_mfma_f32_16x16x32_bf16 v[76:79], a[140:143], v[140:143], v[76:79]
    global_load_dwordx4 v[116:119], v10, s[28:29] sc1
    s_waitcnt vmcnt(11)
    v_mfma_f32_16x16x32_bf16 v[32:35], a[128:131], v[144:147], v[32:35]
    v_mfma_f32_16x16x32_bf16 v[48:51], a[132:135], v[144:147], v[48:51]
    v_mfma_f32_16x16x32_bf16 v[64:67], a[136:139], v[144:147], v[64:67]
    v_mfma_f32_16x16x32_bf16 v[80:83], a[140:143], v[144:147], v[80:83]
    global_load_dwordx4 v[120:123], v11, s[28:29] sc1
    s_waitcnt vmcnt(11)
    v_mfma_f32_16x16x32_bf16 v[20:23], a[128:131], v[132:135], v[20:23]
    v_mfma_f32_16x16x32_bf16 v[36:39], a[132:135], v[132:135], v[36:39]
    v_mfma_f32_16x16x32_bf16 v[52:55], a[136:139], v[132:135], v[52:55]
    v_mfma_f32_16x16x32_bf16 v[68:71], a[140:143], v[132:135], v[68:71]
    global_load_dwordx4 v[108:111], v8, s[28:29] sc1
    s_waitcnt vmcnt(11)
    v_mfma_f32_16x16x32_bf16 v[24:27], a[144:147], v[152:155], v[24:27]
    s_add_u32 s14, s55, 20480
    s_add_u32 s28, s26, s14
    s_addc_u32 s29, s27, 0
    v_mfma_f32_16x16x32_bf16 v[40:43], a[148:151], v[152:155], v[40:43]
    v_mfma_f32_16x16x32_bf16 v[56:59], a[152:155], v[152:155], v[56:59]
    v_mfma_f32_16x16x32_bf16 v[72:75], a[156:159], v[152:155], v[72:75]
    global_load_dwordx4 v[136:139], v9, s[28:29] sc1
    s_waitcnt vmcnt(11)
    v_mfma_f32_16x16x32_bf16 v[28:31], a[144:147], v[156:159], v[28:31]
    v_mfma_f32_16x16x32_bf16 v[44:47], a[148:151], v[156:159], v[44:47]
    v_mfma_f32_16x16x32_bf16 v[60:63], a[152:155], v[156:159], v[60:63]
    v_mfma_f32_16x16x32_bf16 v[76:79], a[156:159], v[156:159], v[76:79]
    global_load_dwordx4 v[140:143], v10, s[28:29] sc1
    s_waitcnt vmcnt(11)
    v_mfma_f32_16x16x32_bf16 v[32:35], a[144:147], v[160:163], v[32:35]
    v_mfma_f32_16x16x32_bf16 v[48:51], a[148:151], v[160:163], v[48:51]
    v_mfma_f32_16x16x32_bf16 v[64:67], a[152:155], v[160:163], v[64:67]
    v_mfma_f32_16x16x32_bf16 v[80:83], a[156:159], v[160:163], v[80:83]
    global_load_dwordx4 v[144:147], v11, s[28:29] sc1
    s_waitcnt vmcnt(11)
    v_mfma_f32_16x16x32_bf16 v[20:23], a[144:147], v[148:151], v[20:23]
    v_mfma_f32_16x16x32_bf16 v[36:39], a[148:151], v[148:151], v[36:39]
    v_mfma_f32_16x16x32_bf16 v[52:55], a[152:155], v[148:151], v[52:55]
    v_mfma_f32_16x16x32_bf16 v[68:71], a[156:159], v[148:151], v[68:71]
    global_load_dwordx4 v[132:135], v8, s[28:29] sc1
    s_waitcnt vmcnt(11)
    v_mfma_f32_16x16x32_bf16 v[24:27], a[160:163], v[96:99], v[24:27]
    s_add_u32 s14, s55, 24576
    s_add_u32 s28, s26, s14
    s_addc_u32 s29, s27, 0
    v_mfma_f32_16x16x32_bf16 v[40:43], a[164:167], v[96:99], v[40:43]
    v_mfma_f32_16x16x32_bf16 v[56:59], a[168:171], v[96:99], v[56:59]
    v_mfma_f32_16x16x32_bf16 v[72:75], a[172:175], v[96:99], v[72:75]
    global_load_dwordx2 v[152:153], v13, s[28:29] sc1
    global_load_dwordx2 v[154:155], v13, s[28:29] offset:512 sc1
    s_waitcnt vmcnt(12)
    v_mfma_f32_16x16x32_bf16 v[28:31], a[160:163], v[100:103], v[28:31]
    v_mfma_f32_16x16x32_bf16 v[44:47], a[164:167], v[100:103], v[44:47]
    v_mfma_f32_16x16x32_bf16 v[60:63], a[168:171], v[100:103], v[60:63]
    v_mfma_f32_16x16x32_bf16 v[76:79], a[172:175], v[100:103], v[76:79]
    global_load_dwordx2 v[156:157], v14, s[28:29] sc1
    global_load_dwordx2 v[158:159], v14, s[28:29] offset:512 sc1
    s_waitcnt vmcnt(13)
    v_mfma_f32_16x16x32_bf16 v[32:35], a[160:163], v[104:107], v[32:35]
    v_mfma_f32_16x16x32_bf16 v[48:51], a[164:167], v[104:107], v[48:51]
    v_mfma_f32_16x16x32_bf16 v[64:67], a[168:171], v[104:107], v[64:67]
    v_mfma_f32_16x16x32_bf16 v[80:83], a[172:175], v[104:107], v[80:83]
    global_load_dwordx2 v[160:161], v15, s[28:29] sc1
    global_load_dwordx2 v[162:163], v15, s[28:29] offset:512 sc1
    s_waitcnt vmcnt(14)
    v_mfma_f32_16x16x32_bf16 v[20:23], a[160:163], v[92:95], v[20:23]
    v_mfma_f32_16x16x32_bf16 v[36:39], a[164:167], v[92:95], v[36:39]
    v_mfma_f32_16x16x32_bf16 v[52:55], a[168:171], v[92:95], v[52:55]
    v_mfma_f32_16x16x32_bf16 v[68:71], a[172:175], v[92:95], v[68:71]
    global_load_dwordx2 v[148:149], v12, s[28:29] sc1
    global_load_dwordx2 v[150:151], v12, s[28:29] offset:512 sc1
    s_waitcnt vmcnt(15)
    v_mfma_f32_16x16x32_bf16 v[24:27], a[176:179], v[112:115], v[24:27]
    v_mfma_f32_16x16x32_bf16 v[40:43], a[180:183], v[112:115], v[40:43]
    v_mfma_f32_16x16x32_bf16 v[56:59], a[184:187], v[112:115], v[56:59]
    v_mfma_f32_16x16x32_bf16 v[72:75], a[188:191], v[112:115], v[72:75]
    s_waitcnt vmcnt(11)
    v_mfma_f32_16x16x32_bf16 v[24:27], a[192:195], v[136:139], v[24:27]
    v_mfma_f32_16x16x32_bf16 v[40:43], a[196:199], v[136:139], v[40:43]
    v_mfma_f32_16x16x32_bf16 v[56:59], a[200:203], v[136:139], v[56:59]
    v_mfma_f32_16x16x32_bf16 v[72:75], a[204:207], v[136:139], v[72:75]
    s_waitcnt vmcnt(6)
    v_mfma_f32_16x16x32_bf16 v[24:27], a[208:211], v[152:155], v[24:27]
    v_mfma_f32_16x16x32_bf16 v[40:43], a[212:215], v[152:155], v[40:43]
    v_mfma_f32_16x16x32_bf16 v[56:59], a[216:219], v[152:155], v[56:59]
    v_mfma_f32_16x16x32_bf16 v[72:75], a[220:223], v[152:155], v[72:75]
    s_waitcnt vmcnt(14)
    v_mfma_f32_16x16x32_bf16 v[28:31], a[176:179], v[116:119], v[28:31]
    v_mfma_f32_16x16x32_bf16 v[44:47], a[180:183], v[116:119], v[44:47]
    v_mfma_f32_16x16x32_bf16 v[60:63], a[184:187], v[116:119], v[60:63]
    v_mfma_f32_16x16x32_bf16 v[76:79], a[188:191], v[116:119], v[76:79]
    s_waitcnt vmcnt(10)
    v_mfma_f32_16x16x32_bf16 v[28:31], a[192:195], v[140:143], v[28:31]
    ds_write_b128 v85, v[24:27] offset:0
    v_mfma_f32_16x16x32_bf16 v[44:47], a[196:199], v[140:143], v[44:47]
    v_mfma_f32_16x16x32_bf16 v[60:63], a[200:203], v[140:143], v[60:63]
    ds_write_b128 v85, v[40:43] offset:1024
    v_mfma_f32_16x16x32_bf16 v[76:79], a[204:207], v[140:143], v[76:79]
    s_waitcnt vmcnt(4)
    v_mfma_f32_16x16x32_bf16 v[28:31], a[208:211], v[156:159], v[28:31]
    ds_write_b128 v85, v[56:59] offset:2048
    v_mfma_f32_16x16x32_bf16 v[44:47], a[212:215], v[156:159], v[44:47]
    v_mfma_f32_16x16x32_bf16 v[60:63], a[216:219], v[156:159], v[60:63]
    ds_write_b128 v85, v[72:75] offset:3072
    v_mfma_f32_16x16x32_bf16 v[76:79], a[220:223], v[156:159], v[76:79]
    s_waitcnt vmcnt(13)
    v_mfma_f32_16x16x32_bf16 v[32:35], a[176:179], v[120:123], v[32:35]
    v_mfma_f32_16x16x32_bf16 v[48:51], a[180:183], v[120:123], v[48:51]
    v_mfma_f32_16x16x32_bf16 v[64:67], a[184:187], v[120:123], v[64:67]
    v_mfma_f32_16x16x32_bf16 v[80:83], a[188:191], v[120:123], v[80:83]
    s_waitcnt vmcnt(9)
    v_mfma_f32_16x16x32_bf16 v[32:35], a[192:195], v[144:147], v[32:35]
    ds_write_b128 v86, v[28:31] offset:4096
    v_mfma_f32_16x16x32_bf16 v[48:51], a[196:199], v[144:147], v[48:51]
    v_mfma_f32_16x16x32_bf16 v[64:67], a[200:203], v[144:147], v[64:67]
    ds_write_b128 v86, v[44:47] offset:5120
    v_mfma_f32_16x16x32_bf16 v[80:83], a[204:207], v[144:147], v[80:83]
    s_waitcnt vmcnt(2)
    v_mfma_f32_16x16x32_bf16 v[32:35], a[208:211], v[160:163], v[32:35]
    ds_write_b128 v86, v[60:63] offset:6144
    v_mfma_f32_16x16x32_bf16 v[48:51], a[212:215], v[160:163], v[48:51]
    v_mfma_f32_16x16x32_bf16 v[64:67], a[216:219], v[160:163], v[64:67]
    ds_write_b128 v86, v[76:79] offset:7168
    v_mfma_f32_16x16x32_bf16 v[80:83], a[220:223], v[160:163], v[80:83]
    s_waitcnt vmcnt(12)
    v_mfma_f32_16x16x32_bf16 v[20:23], a[176:179], v[108:111], v[20:23]
    v_mfma_f32_16x16x32_bf16 v[36:39], a[180:183], v[108:111], v[36:39]
    v_mfma_f32_16x16x32_bf16 v[52:55], a[184:187], v[108:111], v[52:55]
    v_mfma_f32_16x16x32_bf16 v[68:71], a[188:191], v[108:111], v[68:71]
    s_waitcnt vmcnt(8)
    v_mfma_f32_16x16x32_bf16 v[20:23], a[192:195], v[132:135], v[20:23]
    ds_write_b128 v87, v[32:35] offset:8192
    v_mfma_f32_16x16x32_bf16 v[36:39], a[196:199], v[132:135], v[36:39]
    v_mfma_f32_16x16x32_bf16 v[52:55], a[200:203], v[132:135], v[52:55]
    ds_write_b128 v87, v[48:51] offset:9216
    v_mfma_f32_16x16x32_bf16 v[68:71], a[204:207], v[132:135], v[68:71]
    s_waitcnt vmcnt(0)
    v_mfma_f32_16x16x32_bf16 v[20:23], a[208:211], v[148:151], v[20:23]
    ds_write_b128 v87, v[64:67] offset:10240
    v_mfma_f32_16x16x32_bf16 v[36:39], a[212:215], v[148:151], v[36:39]
    v_mfma_f32_16x16x32_bf16 v[52:55], a[216:219], v[148:151], v[52:55]
    ds_write_b128 v87, v[80:83] offset:11264
    v_mfma_f32_16x16x32_bf16 v[68:71], a[220:223], v[148:151], v[68:71]
    s_waitcnt lgkmcnt(0)
    s_barrier
    ds_read_b128 v[92:95], v84 offset:0
    ds_read_b128 v[96:99], v84 offset:4096
    ds_read_b128 v[100:103], v84 offset:8192
    ds_read_b128 v[104:107], v84 offset:1024
    ds_read_b128 v[108:111], v84 offset:5120
    ds_read_b128 v[112:115], v84 offset:9216
    ds_read_b128 v[116:119], v84 offset:2048
    ds_read_b128 v[120:123], v84 offset:6144
    ds_read_b128 v[124:127], v84 offset:10240
    ds_read_b128 v[128:131], v84 offset:3072
    ds_read_b128 v[132:135], v84 offset:7168
    ds_read_b128 v[136:139], v84 offset:11264
    s_waitcnt lgkmcnt(9)
    v_pk_add_f32 v[20:21], v[20:21], v[92:93]
    v_pk_add_f32 v[22:23], v[22:23], v[94:95]
    v_pk_add_f32 v[20:21], v[20:21], v[96:97]
    v_pk_add_f32 v[22:23], v[22:23], v[98:99]
    v_pk_add_f32 v[20:21], v[20:21], v[100:101]
    v_pk_add_f32 v[22:23], v[22:23], v[102:103]
    v_pk_fma_f32 v[20:21], v[20:21], v[236:237], v[172:173]
    v_pk_fma_f32 v[22:23], v[22:23], v[238:239], v[174:175]
    s_waitcnt lgkmcnt(6)
    v_pk_add_f32 v[36:37], v[36:37], v[104:105]
    v_pk_add_f32 v[38:39], v[38:39], v[106:107]
    v_pk_add_f32 v[36:37], v[36:37], v[108:109]
    v_pk_add_f32 v[38:39], v[38:39], v[110:111]
    v_pk_add_f32 v[36:37], v[36:37], v[112:113]
    v_pk_add_f32 v[38:39], v[38:39], v[114:115]
    v_pk_fma_f32 v[36:37], v[36:37], v[240:241], v[176:177]
    v_pk_fma_f32 v[38:39], v[38:39], v[242:243], v[178:179]
    v_cvt_pk_bf16_f32 v228, v20, v36
    v_cvt_pk_bf16_f32 v229, v21, v37
    v_cvt_pk_bf16_f32 v230, v22, v38
    v_cvt_pk_bf16_f32 v231, v23, v39
    global_store_dwordx4 v16, v[228:231], s[92:93] offset:0
    s_waitcnt lgkmcnt(3)
    v_pk_add_f32 v[52:53], v[52:53], v[116:117]
    v_pk_add_f32 v[54:55], v[54:55], v[118:119]
    v_pk_add_f32 v[52:53], v[52:53], v[120:121]
    v_pk_add_f32 v[54:55], v[54:55], v[122:123]
    v_pk_add_f32 v[52:53], v[52:53], v[124:125]
    v_pk_add_f32 v[54:55], v[54:55], v[126:127]
    v_pk_fma_f32 v[52:53], v[52:53], v[244:245], v[180:181]
    v_pk_fma_f32 v[54:55], v[54:55], v[246:247], v[182:183]
    s_waitcnt lgkmcnt(0)
    v_pk_add_f32 v[68:69], v[68:69], v[128:129]
    v_pk_add_f32 v[70:71], v[70:71], v[130:131]
    v_pk_add_f32 v[68:69], v[68:69], v[132:133]
    v_pk_add_f32 v[70:71], v[70:71], v[134:135]
    v_pk_add_f32 v[68:69], v[68:69], v[136:137]
    v_pk_add_f32 v[70:71], v[70:71], v[138:139]
    v_pk_fma_f32 v[68:69], v[68:69], v[248:249], v[184:185]
    v_pk_fma_f32 v[70:71], v[70:71], v[250:251], v[186:187]
    v_cvt_pk_bf16_f32 v232, v52, v68
    v_cvt_pk_bf16_f32 v233, v53, v69
    v_cvt_pk_bf16_f32 v234, v54, v70
    v_cvt_pk_bf16_f32 v235, v55, v71
    global_store_dwordx4 v16, v[232:235], s[92:93] offset:64
    s_endpgm
k_end:
    s_endpgm
code_end:
.section .rodata,"a"
.p2align 6
.amdhsa_kernel adaLN_cond__ssm_conv_s4__dense_activation_silu__prompt_kernel
  .amdhsa_next_free_vgpr 480
  .amdhsa_next_free_sgpr 100
  .amdhsa_accum_offset 256
  .amdhsa_group_segment_fixed_size 0
  .amdhsa_kernarg_size 136
  .amdhsa_user_sgpr_count 2
  .amdhsa_user_sgpr_kernarg_segment_ptr 1
  .amdhsa_system_sgpr_workgroup_id_x 1
.end_amdhsa_kernel
```
